```python
import torch

def _softmax(x, axis=-1):
    return torch.softmax(x, dim=axis)

def _gelu(x):
    return torch.nn.functional.gelu(x, approximate='tanh')

def _silu(x):
    return torch.nn.functional.silu(x)

def _sigmoid(x):
    return torch.sigmoid(x)

def _layernorm(x, axis=-1, eps=1e-05):
    m = x.mean(dim=axis, keepdim=True)
    v = x.var(dim=axis, keepdim=True, unbiased=False)
    return (x - m) / torch.sqrt(v + eps)

def _scatter_add(tgt, idx, src, axis=0):
    return tgt.clone().index_add_(axis, idx, src)

def _segment_sum(src, seg, n):
    out = torch.zeros((n,) + src.shape[1:], dtype=src.dtype)
    return out.index_add_(0, seg, src)

def _pad(x, pw):
    flat = tuple((v for pair in reversed(pw) for v in pair))
    return torch.nn.functional.pad(x, flat)
kernel_name = 'adaLN_cond__spectral_gfnet__moe_arch_mod__prompt'

def setup_inputs():

    _w = lambda a: (lambda t: t.to(torch.bfloat16) if t.is_floating_point() else t)(torch.as_tensor(a))

    def _A_setup():
        B, S, D = (1, 2048, 640)
        Df = D // 2 + 1
        return {'x': _w((lambda *s: torch.randn(*s, dtype=torch.bfloat16) * 0.05)(B, S, D)), 'w_r': _w((lambda *s: torch.randn(*s, dtype=torch.bfloat16) * 3.2)(S, Df) * 0.02), 'w_i': _w((lambda *s: torch.randn(*s, dtype=torch.bfloat16) * 3.2)(S, Df) * 0.02)}
    _A_in = _A_setup()

    def _B_setup():
        B, S, D, F, C = (1, 2048, 640, 1536, 1)
        return {'x': _w((lambda *s: torch.randn(*s, dtype=torch.bfloat16) * 0.05)(B, S, D)), 'w_r': _w((lambda *s: torch.randn(*s, dtype=torch.bfloat16) * 0.05)(D)), 'w_gate': _w((lambda *s: torch.randn(*s, dtype=torch.bfloat16) * 0.05)(D, F)), 'w_up': _w((lambda *s: torch.randn(*s, dtype=torch.bfloat16) * 0.05)(D, F)), 'w_down': _w((lambda *s: torch.randn(*s, dtype=torch.bfloat16) * 0.05)(F, D))}
    _B_in = _B_setup()
    return {'A_x': _A_in['x'], 'A_w_r': _A_in['w_r'], 'A_w_i': _A_in['w_i'], 'B_x': _B_in['x'], 'B_w_r': _B_in['w_r'], 'B_w_gate': _B_in['w_gate'], 'B_w_up': _B_in['w_up'], 'B_w_down': _B_in['w_down'], 'c': _w((lambda *s: torch.randn(*s, dtype=torch.bfloat16) * 0.1)(1, 640) * 8.0), 'w_mod': _w((lambda *s: torch.randn(*s, dtype=torch.bfloat16) * 0.1)(640, 6 * 640) * 640 ** (-0.5) * 8.0)}

def reference(A_x, A_w_r, A_w_i, B_x, B_w_r, B_w_gate, B_w_up, B_w_down, c, w_mod):

    def _A_ref(x, w_r, w_i):
        B, S, D = x.shape
        X = (lambda x, axes=(-2, -1): torch.fft.rfft2(x.float(), dim=axes))(x, axes=(-2, -1))
        W = w_r + 1j * w_i
        X = X * W
        y = (lambda x, s, axes=(-2, -1): torch.fft.irfft2(x, s=s, dim=axes).to(torch.bfloat16))(X, (S, D), axes=(-2, -1))
        return y

    def _B_ref(x, w_r, w_gate, w_up, w_down):
        B, S, D = x.shape
        C = 1
        r = x @ w_r
        idx = torch.argsort(-r, axis=-1)[:, :C]
        idx_e = (lambda x, n, axis: torch.repeat_interleave(x, n, dim=axis))(idx.reshape(B, C, 1), D, axis=2)
        x_sel = (lambda x, i, axis: torch.take_along_dim(x, i, dim=axis))(x, idx_e, axis=1)
        g = _silu(x_sel @ w_gate)
        u = x_sel @ w_up
        y = g * u @ w_down
        r_sel = _sigmoid((lambda x, i, axis: torch.take_along_dim(x, i, dim=axis))(r, idx, axis=1))
        y = y * r_sel.reshape(B, C, 1)
        b_off = (torch.arange(B) * S).reshape(B, 1)
        flat_idx = (idx + b_off).reshape(B * C)
        zero = (x * 0.0).reshape(B * S, D)
        upd = _scatter_add(zero, flat_idx, y.reshape(B * C, D), axis=0)
        return x + upd.reshape(B, S, D)
    x = A_x
    mod = (_silu(c) @ w_mod).reshape(c.shape[0], 6, 1, -1)
    sa, ca, ga, sb, cb, gb = (mod[:, 0].clone(), mod[:, 1].clone(), mod[:, 2].clone(), mod[:, 3].clone(), mod[:, 4].clone(), mod[:, 5].clone())
    h = _layernorm(x, axis=-1) * (1 + ca) + sa
    x = x + ga * _A_ref(h, A_w_r, A_w_i)
    h = _layernorm(x, axis=-1) * (1 + cb) + sb
    x = x + gb * _B_ref(h, B_w_r, B_w_gate, B_w_up, B_w_down)
    return x
```

```asm
; @launch grid=(256,1,1) block=(512,1,1) lds=101264
.amdgcn_target "amdgcn-amd-amdhsa--gfx950"
.text
.globl adaLN_cond__spectral_gfnet__moe_arch_mod__prompt_kernel
.p2align 8
.type adaLN_cond__spectral_gfnet__moe_arch_mod__prompt_kernel,@function
adaLN_cond__spectral_gfnet__moe_arch_mod__prompt_kernel:
    s_cmp_ge_u32 s2, 256
    s_cbranch_scc1 k0_end
    s_load_dwordx8 s[20:27], s[0:1], 64
    s_load_dwordx16 s[4:19], s[0:1], 0
    s_load_dwordx2 s[28:29], s[0:1], 96
    v_lshrrev_b32 v1, 6, v0
    s_getpc_b64 s[40:41]
    v_readfirstlane_b32 s30, v1
    s_bfe_u32 s48, s2, 0x40003
    v_lshl_add_u32 v5, v0, 4, s48
    v_cmp_gt_u32 vcc, 174, v5
    v_lshlrev_b32 v5, 7, v5
    s_and_saveexec_b64 s[42:43], vcc
    s_cbranch_execz Lnopref
    global_load_dword v234, v5, s[40:41]
Lnopref:
    s_mov_b64 exec, -1
    s_and_b32 s48, s2, 7
    s_lshr_b32 s49, s2, 3
    s_min_u32 s49, s49, 24
    s_mul_i32 s48, s48, 25
    s_add_u32 s48, s48, s49
    s_mul_i32 s57, s48, 1639
    s_lshr_b32 s57, s57, 16
    s_mul_i32 s49, s57, 40
    s_sub_u32 s56, s48, s49
    v_and_b32 v48, 60, v0
    s_lshl_b32 s48, s57, 8
    v_add_u32 v48, s48, v48
    v_mul_u32_u24 v44, 3840, v48
    v_and_b32 v45, 3, v0
    v_lshl_add_u32 v44, v45, 4, v44
    v_lshl_add_u32 v48, v45, 6, v48
    s_lshl_b32 s48, s56, 6
    v_add_u32 v44, s48, v44
    v_add_u32 v45, 245760, v44
    v_add_u32 v46, 491520, v44
    v_add_u32 v47, 737280, v44
    s_cmp_lg_u32 s30, 7
    s_cbranch_scc1 Lnomod1
    s_setprio 3
    s_cmp_ge_u32 s2, 200
    s_cbranch_scc1 Lw7b
    s_waitcnt lgkmcnt(0)
    global_load_dword v20, v48, s[20:21]
    s_add_u32 s40, s22, 7680
    s_addc_u32 s41, s23, 0
    global_load_dwordx4 v[72:75], v44, s[22:23]
    global_load_dwordx4 v[76:79], v44, s[40:41]
    global_load_dwordx4 v[80:83], v45, s[22:23]
    global_load_dwordx4 v[84:87], v45, s[40:41]
    global_load_dwordx4 v[88:91], v46, s[22:23]
    global_load_dwordx4 v[92:95], v46, s[40:41]
    global_load_dwordx4 v[96:99], v47, s[22:23]
    global_load_dwordx4 v[100:103], v47, s[40:41]
    v_mov_b32 v64, 0
    v_mov_b32 v68, 0
    v_lshlrev_b32 v232, 4, v0
    v_and_b32 v0, 63, v0
    v_lshlrev_b32 v1, 2, v0
    v_lshlrev_b32 v233, 4, v0
    v_and_b32 v2, 15, v0
    v_lshrrev_b32 v3, 4, v0
    s_lshl_b32 s37, s30, 8
    s_add_u32 s37, s37, s2
    s_mul_i32 s55, s37, 1280
    s_lshr_b32 s32, s30, 1
    s_and_b32 s33, s30, 1
    s_mov_b32 s58, 0x05040100
    s_mov_b32 s59, 0x07060302
    s_mov_b32 s36, 0x40004000
    s_and_b32 s48, s2, 7
    s_mul_i32 s39, s48, 105728
    s_add_u32 s39, s39, 524288
    s_lshr_b32 s49, s2, 6
    s_add_u32 s49, s49, 1
    s_cmp_lt_u32 s2, 128
    s_cselect_b32 s49, s49, 0
    s_bfe_u32 s50, s2, 0x30003
    s_sub_u32 s51, 0, s48
    s_and_b32 s51, s51, 7
    s_cmp_lt_u32 s50, 4
    s_cselect_b32 s51, s48, s51
    s_lshl_b32 s35, s49, 3
    s_add_u32 s35, s35, s51
    s_lshl_b32 s35, s35, 3
    s_add_u32 s35, s35, s50
    s_load_dword s31, s[28:29], 0
    s_add_u32 s4, s4, s55
    s_addc_u32 s5, s5, 0
    s_mov_b64 s[26:27], s[24:25]
    s_add_u32 s24, s24, s55
    s_addc_u32 s25, s25, 0
    s_mul_i32 s48, s57, 15360
    s_lshl_b32 s49, s56, 7
    s_add_u32 s48, s48, s49
    s_sub_u32 s50, s2, 200
    s_lshl_b32 s50, s50, 7
    s_add_u32 s50, s50, 76800
    s_cmp_ge_u32 s2, 200
    s_cselect_b32 s48, s50, s48
    s_add_u32 s48, s48, 524288
    v_lshrrev_b32 v49, 3, v0
    v_mul_u32_u24 v49, 105728, v49
    v_and_b32 v50, 7, v0
    v_lshl_add_u32 v49, v50, 4, v49
    v_add_u32 v49, s48, v49
    v_and_b32 v51, 1, v0
    v_and_b32 v50, 6, v0
    v_lshlrev_b32 v50, 1, v50
    v_lshl_add_u32 v50, v51, 7, v50
    v_add_u32 v51, 64, v50
    v_lshrrev_b32 v48, 3, v0
    v_mul_u32_u24 v44, 15360, v48
    v_and_b32 v48, 7, v0
    v_lshl_add_u32 v44, v48, 4, v44
    s_mul_i32 s48, s57, 983040
    s_lshl_b32 s49, s56, 7
    s_add_u32 s48, s48, s49
    s_add_u32 s48, s48, 2560
    v_add_u32 v44, s48, v44
    s_cmp_lt_u32 s56, 20
    s_cselect_b32 s50, 0x2b800000, 1.0
    s_waitcnt vmcnt(8)
    v_lshlrev_b32 v28, 16, v20
    v_and_b32 v29, 0xffff0000, v20
    v_mul_f32 v30, 0xbfb8aa3b, v28
    v_mul_f32 v31, 0xbfb8aa3b, v29
    v_exp_f32 v30, v30
    v_exp_f32 v31, v31
    v_add_f32 v30, 1.0, v30
    v_add_f32 v31, 1.0, v31
    v_rcp_f32 v30, v30
    v_rcp_f32 v31, v31
    s_nop 0
    v_pk_mul_f32 v[28:29], v[28:29], v[30:31]
    v_cvt_pk_bf16_f32 v20, v28, v29
    v_pk_mul_f32 v[28:29], v[28:29], s[50:51] op_sel_hi:[1,0]
    v_cvt_pk_bf16_f32 v21, v28, v29
    s_nop 1
    v_mov_b32_dpp v12, v21 quad_perm:[0,0,0,0] row_mask:0xf bank_mask:0xf
    v_mov_b32_dpp v13, v21 quad_perm:[1,1,1,1] row_mask:0xf bank_mask:0xf
    v_mov_b32_dpp v14, v21 quad_perm:[2,2,2,2] row_mask:0xf bank_mask:0xf
    v_mov_b32_dpp v15, v21 quad_perm:[3,3,3,3] row_mask:0xf bank_mask:0xf
    s_waitcnt lgkmcnt(0)
    s_lshl_b32 s48, s31, 16
    s_xor_b32 s31, s31, s48
    s_xor_b32 s31, s31, 0xffff
    v_mov_b32 v241, s31
    s_waitcnt vmcnt(6)
    v_perm_b32 v22, v76, v72, s58
    v_perm_b32 v23, v76, v72, s59
    v_dot2_f32_bf16 v28, v22, v12, 0
    v_dot2_f32_bf16 v29, v23, v12, 0
    v_perm_b32 v24, v77, v73, s58
    v_perm_b32 v25, v77, v73, s59
    v_dot2_f32_bf16 v30, v24, v12, 0
    v_dot2_f32_bf16 v31, v25, v12, 0
    v_perm_b32 v22, v78, v74, s58
    v_perm_b32 v23, v78, v74, s59
    v_dot2_f32_bf16 v32, v22, v12, 0
    v_dot2_f32_bf16 v33, v23, v12, 0
    v_perm_b32 v24, v79, v75, s58
    v_perm_b32 v25, v79, v75, s59
    v_dot2_f32_bf16 v34, v24, v12, 0
    v_dot2_f32_bf16 v35, v25, v12, 0
    s_waitcnt vmcnt(4)
    v_perm_b32 v22, v84, v80, s58
    v_perm_b32 v23, v84, v80, s59
    v_dot2_f32_bf16 v28, v22, v13, v28
    v_dot2_f32_bf16 v29, v23, v13, v29
    v_perm_b32 v24, v85, v81, s58
    v_perm_b32 v25, v85, v81, s59
    v_dot2_f32_bf16 v30, v24, v13, v30
    v_dot2_f32_bf16 v31, v25, v13, v31
    v_perm_b32 v22, v86, v82, s58
    v_perm_b32 v23, v86, v82, s59
    v_dot2_f32_bf16 v32, v22, v13, v32
    v_dot2_f32_bf16 v33, v23, v13, v33
    v_perm_b32 v24, v87, v83, s58
    v_perm_b32 v25, v87, v83, s59
    v_dot2_f32_bf16 v34, v24, v13, v34
    v_dot2_f32_bf16 v35, v25, v13, v35
    s_waitcnt vmcnt(2)
    v_perm_b32 v22, v92, v88, s58
    v_perm_b32 v23, v92, v88, s59
    v_dot2_f32_bf16 v28, v22, v14, v28
    v_dot2_f32_bf16 v29, v23, v14, v29
    v_perm_b32 v24, v93, v89, s58
    v_perm_b32 v25, v93, v89, s59
    v_dot2_f32_bf16 v30, v24, v14, v30
    v_dot2_f32_bf16 v31, v25, v14, v31
    v_perm_b32 v22, v94, v90, s58
    v_perm_b32 v23, v94, v90, s59
    v_dot2_f32_bf16 v32, v22, v14, v32
    v_dot2_f32_bf16 v33, v23, v14, v33
    v_perm_b32 v24, v95, v91, s58
    v_perm_b32 v25, v95, v91, s59
    v_dot2_f32_bf16 v34, v24, v14, v34
    v_dot2_f32_bf16 v35, v25, v14, v35
    s_waitcnt vmcnt(0)
    v_perm_b32 v22, v100, v96, s58
    v_perm_b32 v23, v100, v96, s59
    v_dot2_f32_bf16 v28, v22, v15, v28
    v_dot2_f32_bf16 v29, v23, v15, v29
    v_perm_b32 v24, v101, v97, s58
    v_perm_b32 v25, v101, v97, s59
    v_dot2_f32_bf16 v30, v24, v15, v30
    v_dot2_f32_bf16 v31, v25, v15, v31
    v_perm_b32 v22, v102, v98, s58
    v_perm_b32 v23, v102, v98, s59
    v_dot2_f32_bf16 v32, v22, v15, v32
    v_dot2_f32_bf16 v33, v23, v15, v33
    v_perm_b32 v24, v103, v99, s58
    v_perm_b32 v25, v103, v99, s59
    v_dot2_f32_bf16 v34, v24, v15, v34
    v_dot2_f32_bf16 v35, v25, v15, v35
    v_permlane32_swap_b32 v28, v32
    v_permlane32_swap_b32 v29, v33
    v_permlane32_swap_b32 v30, v34
    v_permlane32_swap_b32 v31, v35
    v_add_f32 v28, v28, v32
    v_add_f32 v29, v29, v33
    v_add_f32 v30, v30, v34
    v_add_f32 v31, v31, v35
    s_nop 0
    v_permlane16_swap_b32 v28, v30
    v_permlane16_swap_b32 v29, v31
    v_add_f32 v28, v28, v30
    v_add_f32 v29, v29, v31
    s_nop 0
    v_add_f32_dpp v28, v28, v28 row_ror:8 row_mask:0xf bank_mask:0xf
    v_add_f32_dpp v29, v29, v29 row_ror:8 row_mask:0xf bank_mask:0xf
    s_nop 0
    v_add_f32_dpp v28, v28, v28 row_ror:4 row_mask:0xf bank_mask:0xf
    v_add_f32_dpp v29, v29, v29 row_ror:4 row_mask:0xf bank_mask:0xf
    ds_bpermute_b32 v32, v50, v28 offset:0
    ds_bpermute_b32 v33, v50, v29 offset:0
    ds_bpermute_b32 v34, v51, v28 offset:0
    ds_bpermute_b32 v35, v51, v29 offset:0
    s_mov_b32 s48, 0x7060500
    s_waitcnt lgkmcnt(3)
    v_perm_b32 v32, v32, v241, s48
    s_mov_b32 s48, 0x7060501
    s_waitcnt lgkmcnt(2)
    v_perm_b32 v33, v33, v241, s48
    s_mov_b32 s48, 0x7060502
    s_waitcnt lgkmcnt(1)
    v_perm_b32 v34, v34, v241, s48
    s_mov_b32 s48, 0x7060503
    s_waitcnt lgkmcnt(0)
    v_perm_b32 v35, v35, v241, s48
    global_store_dwordx4 v49, v[32:35], s[28:29] offset:0 sc1
    global_load_dword v4, v1, s[4:5] offset:0
    global_load_dword v5, v1, s[4:5] offset:256
    global_load_dword v6, v1, s[4:5] offset:512
    global_load_dword v7, v1, s[4:5] offset:768
    global_load_dword v8, v1, s[4:5] offset:1024
    v_lshrrev_b32 v45, 3, v0
    v_lshlrev_b32 v45, 4, v45
    ds_bpermute_b32 v12, v45, v20 offset:0
    ds_bpermute_b32 v13, v45, v20 offset:128
    ds_bpermute_b32 v14, v45, v20 offset:4
    ds_bpermute_b32 v15, v45, v20 offset:132
    ds_bpermute_b32 v16, v45, v20 offset:8
    ds_bpermute_b32 v17, v45, v20 offset:136
    ds_bpermute_b32 v18, v45, v20 offset:12
    ds_bpermute_b32 v19, v45, v20 offset:140
    s_lshl_b32 s49, s56, 7
    s_add_u32 s49, s49, 5120
    v_add_u32 v49, s49, v49
    s_waitcnt lgkmcnt(0)
    s_add_u32 s40, s22, 7680
    s_addc_u32 s41, s23, 0
    global_load_dwordx4 v[160:163], v44, s[22:23]
    global_load_dwordx4 v[164:167], v44, s[40:41]
    v_add_u32 v44, 122880, v44
    global_load_dwordx4 v[168:171], v44, s[22:23]
    global_load_dwordx4 v[172:175], v44, s[40:41]
    v_add_u32 v44, 122880, v44
    global_load_dwordx4 v[176:179], v44, s[22:23]
    global_load_dwordx4 v[180:183], v44, s[40:41]
    v_add_u32 v44, 122880, v44
    global_load_dwordx4 v[184:187], v44, s[22:23]
    global_load_dwordx4 v[188:191], v44, s[40:41]
    v_add_u32 v44, 122880, v44
    global_load_dwordx4 v[192:195], v44, s[22:23]
    global_load_dwordx4 v[196:199], v44, s[40:41]
    v_add_u32 v44, 122880, v44
    global_load_dwordx4 v[200:203], v44, s[22:23]
    global_load_dwordx4 v[204:207], v44, s[40:41]
    v_add_u32 v44, 122880, v44
    global_load_dwordx4 v[208:211], v44, s[22:23]
    global_load_dwordx4 v[212:215], v44, s[40:41]
    v_add_u32 v44, 122880, v44
    global_load_dwordx4 v[216:219], v44, s[22:23]
    global_load_dwordx4 v[220:223], v44, s[40:41]
    s_setprio 1
    v_and_b32 v114, 3, v0
    v_lshl_add_u32 v115, v114, 2, 18
    v_alignbit_b32 v236, s31, s31, v115
    v_and_b32 v236, s36, v236
    v_add_u32 v115, 1, v115
    v_alignbit_b32 v237, s31, s31, v115
    v_and_b32 v237, s36, v237
    v_add_u32 v115, 1, v115
    v_alignbit_b32 v238, s31, s31, v115
    v_and_b32 v238, s36, v238
    v_add_u32 v115, 1, v115
    v_alignbit_b32 v239, s31, s31, v115
    v_and_b32 v239, s36, v239
    v_add_u32 v115, 18, v2
    v_alignbit_b32 v240, s31, s31, v115
    v_and_b32 v240, s36, v240
    s_mul_i32 s48, s30, 272
    s_add_u32 s48, s48, 15360
    v_add_u32 v142, s48, v1
    s_mov_b32 s60, 0x3e9e377a
    s_mov_b32 s62, 0xbf4f1bbd
    s_mov_b32 s64, 0xbf737871
    s_mov_b32 s66, 0xbf167918
    v_mul_u32_u24 v144, 544, v3
    v_lshrrev_b32 v145, 2, v2
    v_lshl_add_u32 v144, v145, 6, v144
    v_and_b32 v145, 3, v2
    v_lshl_add_u32 v144, v145, 3, v144
    s_lshl_b32 s48, s32, 1
    s_max_u32 s48, s48, 1
    s_sub_u32 s48, s48, 1
    s_mul_i32 s48, s48, 2176
    s_add_u32 s48, s48, 15360
    v_add_u32 v144, s48, v144
    s_lshl_b32 s48, s30, 11
    s_mul_i32 s49, s2, 12544
    s_add_u32 s49, s48, s49
    s_add_u32 s49, s49, 2097152
    v_lshlrev_b32 v145, 9, v3
    v_lshl_add_u32 v145, v2, 4, v145
    s_add_u32 s42, s28, s49
    s_addc_u32 s43, s29, 0
    s_mul_i32 s49, s35, 16640
    s_add_u32 s48, s48, s49
    s_add_u32 s48, s48, 6291456
    s_add_u32 s44, s28, s48
    s_addc_u32 s45, s29, 0
    s_lshr_b32 s49, s35, 6
    s_and_b32 s50, s35, 7
    s_bfe_u32 s51, s35, 0x30003
    s_cmp_lt_u32 s50, 4
    s_cselect_b32 s52, 1, -1
    s_cselect_b32 s53, 0, 640
    s_lshl_b32 s50, s50, 4
    v_add_u32 v112, s50, v2
    v_mad_u32_u24 v112, v112, 5, s49
    v_mul_i32_i24 v112, s52, v112
    v_add_lshl_u32 v112, v112, s53, 1
    s_lshl_b32 s50, s30, 4
    s_add_u32 s50, s50, s51
    v_lshl_add_u32 v113, v3, 9, s50
    v_mul_i32_i24 v113, s52, v113
    s_movk_i32 s53, 642
    v_and_b32 v224, 2047, v113
    v_mad_u32_u24 v224, v224, s53, v112
    s_mul_i32 s48, s52, 128
    v_add_u32 v225, s48, v113
    v_and_b32 v225, 2047, v225
    v_mad_u32_u24 v225, v225, s53, v112
    s_mul_i32 s48, s52, 256
    v_add_u32 v226, s48, v113
    v_and_b32 v226, 2047, v226
    v_mad_u32_u24 v226, v226, s53, v112
    s_mul_i32 s48, s52, 384
    v_add_u32 v227, s48, v113
    v_and_b32 v227, 2047, v227
    v_mad_u32_u24 v227, v227, s53, v112
    s_mul_i32 s48, s52, 8
    v_add_u32 v228, s48, v113
    v_and_b32 v228, 2047, v228
    v_mad_u32_u24 v228, v228, s53, v112
    s_mul_i32 s48, s52, 136
    v_add_u32 v229, s48, v113
    v_and_b32 v229, 2047, v229
    v_mad_u32_u24 v229, v229, s53, v112
    s_mul_i32 s48, s52, 264
    v_add_u32 v230, s48, v113
    v_and_b32 v230, 2047, v230
    v_mad_u32_u24 v230, v230, s53, v112
    s_mul_i32 s48, s52, 392
    v_add_u32 v231, s48, v113
    v_and_b32 v231, 2047, v231
    v_mad_u32_u24 v231, v231, s53, v112
    s_and_b32 s48, s2, 7
    s_mul_i32 s48, s48, 384
    s_add_u32 s48, s48, 327680
    v_mul_u32_u24 v235, 6144, v0
    v_add_u32 v235, s48, v235
    s_cmp_eq_u32 s32, 0
    s_cselect_b32 s0, 0x00ff00ff, -1
    s_mov_b32 s1, s0
    s_cmp_ge_u32 s2, 168
    s_cbranch_scc1 Lc27
    v_cvt_f32_u32 v114, v2
    v_mul_f32 v114, 0x3b800000, v114
    v_lshlrev_b32 v115, 6, v3
    s_lshl_b32 s48, s30, 1
    v_add_u32 v116, s48, v115
    v_cvt_f32_u32 v115, v115
    v_cvt_f32_u32 v116, v116
    v_mul_f32 v115, v115, v114
    v_mul_f32 v116, v116, v114
    v_cos_f32 v118, v116
    v_sin_f32 v119, v116
    s_nop 0
    v_cvt_pk_bf16_f32 v88, v118, v119
    v_cvt_pk_bf16_f32 v92, -v119, v118
    v_fmamk_f32 v117, v114, 0x41800000, v116
    v_cos_f32 v118, v117
    v_sin_f32 v119, v117
    s_nop 0
    v_cvt_pk_bf16_f32 v89, v118, v119
    v_cvt_pk_bf16_f32 v93, -v119, v118
    v_fmamk_f32 v117, v114, 0x42000000, v116
    v_cos_f32 v118, v117
    v_sin_f32 v119, v117
    s_nop 0
    v_cvt_pk_bf16_f32 v90, v118, v119
    v_cvt_pk_bf16_f32 v94, -v119, v118
    v_fmamk_f32 v117, v114, 0x42400000, v116
    v_cos_f32 v118, v117
    v_sin_f32 v119, v117
    s_nop 0
    v_cvt_pk_bf16_f32 v91, v118, v119
    v_cvt_pk_bf16_f32 v95, -v119, v118
    v_fmamk_f32 v117, v114, 0x3f800000, v116
    v_cos_f32 v118, v117
    v_sin_f32 v119, v117
    s_nop 0
    v_cvt_pk_bf16_f32 v96, v118, v119
    v_cvt_pk_bf16_f32 v100, -v119, v118
    v_fmamk_f32 v117, v114, 0x41880000, v116
    v_cos_f32 v118, v117
    v_sin_f32 v119, v117
    s_nop 0
    v_cvt_pk_bf16_f32 v97, v118, v119
    v_cvt_pk_bf16_f32 v101, -v119, v118
    v_fmamk_f32 v117, v114, 0x42040000, v116
    v_cos_f32 v118, v117
    v_sin_f32 v119, v117
    s_nop 0
    v_cvt_pk_bf16_f32 v98, v118, v119
    v_cvt_pk_bf16_f32 v102, -v119, v118
    v_fmamk_f32 v117, v114, 0x42440000, v116
    v_cos_f32 v118, v117
    v_sin_f32 v119, v117
    s_nop 0
    v_cvt_pk_bf16_f32 v99, v118, v119
    v_cvt_pk_bf16_f32 v103, -v119, v118
    v_cos_f32 v118, v115
    v_sin_f32 v119, v115
    s_nop 0
    v_cvt_pk_bf16_f32 v104, v118, v119
    v_cvt_pk_bf16_f32 v108, -v119, v118
    v_fmamk_f32 v117, v114, 0x41800000, v115
    v_cos_f32 v118, v117
    v_sin_f32 v119, v117
    s_nop 0
    v_cvt_pk_bf16_f32 v105, v118, v119
    v_cvt_pk_bf16_f32 v109, -v119, v118
    v_fmamk_f32 v117, v114, 0x42000000, v115
    v_cos_f32 v118, v117
    v_sin_f32 v119, v117
    s_nop 0
    v_cvt_pk_bf16_f32 v106, v118, v119
    v_cvt_pk_bf16_f32 v110, -v119, v118
    v_fmamk_f32 v117, v114, 0x42400000, v115
    v_cos_f32 v118, v117
    v_sin_f32 v119, v117
    s_nop 0
    v_cvt_pk_bf16_f32 v107, v118, v119
    v_cvt_pk_bf16_f32 v111, -v119, v118
Lc27:
    v_mov_b32 v112, 100224
    s_waitcnt vmcnt(21)
    ds_write_b32 v112, v241 offset:4
    ds_write_b32 v112, v241
    s_setprio 0
    s_waitcnt vmcnt(16)
    v_lshlrev_b32 v132, 16, v4
    v_and_b32 v133, 0xffff0000, v4
    v_lshlrev_b32 v134, 16, v5
    v_and_b32 v135, 0xffff0000, v5
    v_lshlrev_b32 v136, 16, v6
    v_and_b32 v137, 0xffff0000, v6
    v_lshlrev_b32 v138, 16, v7
    v_and_b32 v139, 0xffff0000, v7
    v_lshlrev_b32 v140, 16, v8
    v_and_b32 v141, 0xffff0000, v8
    v_pk_add_f32 v[112:113], v[132:133], v[134:135]
    v_pk_mul_f32 v[114:115], v[132:133], v[132:133]
    v_pk_fma_f32 v[114:115], v[134:135], v[134:135], v[114:115]
    v_pk_add_f32 v[112:113], v[112:113], v[136:137]
    v_pk_fma_f32 v[114:115], v[136:137], v[136:137], v[114:115]
    v_pk_add_f32 v[112:113], v[112:113], v[138:139]
    v_pk_fma_f32 v[114:115], v[138:139], v[138:139], v[114:115]
    v_pk_add_f32 v[112:113], v[112:113], v[140:141]
    v_pk_fma_f32 v[114:115], v[140:141], v[140:141], v[114:115]
    v_add_f32 v112, v112, v113
    v_add_f32 v114, v114, v115
    s_nop 0
    v_add_f32_dpp v112, v112, v112 row_ror:8 row_mask:0xf bank_mask:0xf
    v_add_f32_dpp v114, v114, v114 row_ror:8 row_mask:0xf bank_mask:0xf
    s_nop 0
    v_add_f32_dpp v112, v112, v112 row_ror:4 row_mask:0xf bank_mask:0xf
    v_add_f32_dpp v114, v114, v114 row_ror:4 row_mask:0xf bank_mask:0xf
    s_nop 0
    v_add_f32_dpp v112, v112, v112 row_ror:2 row_mask:0xf bank_mask:0xf
    v_add_f32_dpp v114, v114, v114 row_ror:2 row_mask:0xf bank_mask:0xf
    s_nop 0
    v_add_f32_dpp v112, v112, v112 row_ror:1 row_mask:0xf bank_mask:0xf
    v_add_f32_dpp v114, v114, v114 row_ror:1 row_mask:0xf bank_mask:0xf
    s_nop 0
    v_add_f32_dpp v112, v112, v112 row_bcast:15 row_mask:0xa bank_mask:0xf
    v_add_f32_dpp v114, v114, v114 row_bcast:15 row_mask:0xa bank_mask:0xf
    s_nop 0
    v_add_f32_dpp v112, v112, v112 row_bcast:31 row_mask:0xc bank_mask:0xf
    v_add_f32_dpp v114, v114, v114 row_bcast:31 row_mask:0xc bank_mask:0xf
    v_readlane_b32 s48, v112, 63
    v_readlane_b32 s49, v114, 63
    v_mov_b32 v112, 0x3acccccd
    v_mul_f32 v113, s48, v112
    v_mul_f32 v114, s49, v112
    v_fma_f32 v114, -v113, v113, v114
    v_max_f32 v114, 0, v114
    v_add_f32 v114, 0x3727c5ac, v114
    v_rsq_f32 v114, v114
    s_nop 0
    v_mul_f32 v114, 0x2b800000, v114
    v_mul_f32_e64 v116, -v113, v114
    v_pk_fma_f32 v[132:133], v[132:133], v[114:115], v[116:117] op_sel_hi:[1,0,0]
    v_pk_fma_f32 v[134:135], v[134:135], v[114:115], v[116:117] op_sel_hi:[1,0,0]
    v_pk_fma_f32 v[136:137], v[136:137], v[114:115], v[116:117] op_sel_hi:[1,0,0]
    v_pk_fma_f32 v[138:139], v[138:139], v[114:115], v[116:117] op_sel_hi:[1,0,0]
    v_pk_fma_f32 v[140:141], v[140:141], v[114:115], v[116:117] op_sel_hi:[1,0,0]
    v_mov_b32 v112, 100224
    s_mov_b32 s34, 100000
    s_add_u32 s48, s31, 5
Lw7w:
    ds_read_b32 v113, v112 offset:4
    s_sub_u32 s34, s34, 1
    s_cbranch_scc1 Lw7wd
    s_waitcnt lgkmcnt(0)
    v_cmp_ne_u32 vcc, s48, v113
    s_cbranch_vccnz Lw7w
Lw7wd:
    s_waitcnt lgkmcnt(0)
    s_cmp_ge_u32 s2, 168
    s_cselect_b64 exec, 1, -1
    global_load_ushort v72, v224, s[6:7]
    global_load_ushort v80, v224, s[8:9]
    global_load_ushort v73, v225, s[6:7]
    global_load_ushort v81, v225, s[8:9]
    global_load_ushort v74, v226, s[6:7]
    global_load_ushort v82, v226, s[8:9]
    global_load_ushort v75, v227, s[6:7]
    global_load_ushort v83, v227, s[8:9]
    global_load_ushort v76, v228, s[6:7]
    global_load_ushort v84, v228, s[8:9]
    global_load_ushort v77, v229, s[6:7]
    global_load_ushort v85, v229, s[8:9]
    global_load_ushort v78, v230, s[6:7]
    global_load_ushort v86, v230, s[8:9]
    global_load_ushort v79, v231, s[6:7]
    global_load_ushort v87, v231, s[8:9]
    s_mov_b64 exec, -1
    s_waitcnt vmcnt(30)
    v_perm_b32 v22, v164, v160, s58
    v_perm_b32 v23, v164, v160, s59
    v_dot2_f32_bf16 v28, v22, v12, 0
    v_dot2_f32_bf16 v29, v23, v12, 0
    v_perm_b32 v24, v165, v161, s58
    v_perm_b32 v25, v165, v161, s59
    v_dot2_f32_bf16 v30, v24, v12, 0
    v_dot2_f32_bf16 v31, v25, v12, 0
    v_perm_b32 v22, v166, v162, s58
    v_perm_b32 v23, v166, v162, s59
    v_dot2_f32_bf16 v32, v22, v12, 0
    v_dot2_f32_bf16 v33, v23, v12, 0
    v_perm_b32 v24, v167, v163, s58
    v_perm_b32 v25, v167, v163, s59
    v_dot2_f32_bf16 v34, v24, v12, 0
    v_dot2_f32_bf16 v35, v25, v12, 0
    s_waitcnt vmcnt(28)
    v_perm_b32 v22, v172, v168, s58
    v_perm_b32 v23, v172, v168, s59
    v_dot2_f32_bf16 v28, v22, v13, v28
    v_dot2_f32_bf16 v29, v23, v13, v29
    v_perm_b32 v24, v173, v169, s58
    v_perm_b32 v25, v173, v169, s59
    v_dot2_f32_bf16 v30, v24, v13, v30
    v_dot2_f32_bf16 v31, v25, v13, v31
    v_perm_b32 v22, v174, v170, s58
    v_perm_b32 v23, v174, v170, s59
    v_dot2_f32_bf16 v32, v22, v13, v32
    v_dot2_f32_bf16 v33, v23, v13, v33
    v_perm_b32 v24, v175, v171, s58
    v_perm_b32 v25, v175, v171, s59
    v_dot2_f32_bf16 v34, v24, v13, v34
    v_dot2_f32_bf16 v35, v25, v13, v35
    s_waitcnt vmcnt(26)
    v_perm_b32 v22, v180, v176, s58
    v_perm_b32 v23, v180, v176, s59
    v_dot2_f32_bf16 v28, v22, v14, v28
    v_dot2_f32_bf16 v29, v23, v14, v29
    v_perm_b32 v24, v181, v177, s58
    v_perm_b32 v25, v181, v177, s59
    v_dot2_f32_bf16 v30, v24, v14, v30
    v_dot2_f32_bf16 v31, v25, v14, v31
    v_perm_b32 v22, v182, v178, s58
    v_perm_b32 v23, v182, v178, s59
    v_dot2_f32_bf16 v32, v22, v14, v32
    v_dot2_f32_bf16 v33, v23, v14, v33
    v_perm_b32 v24, v183, v179, s58
    v_perm_b32 v25, v183, v179, s59
    v_dot2_f32_bf16 v34, v24, v14, v34
    v_dot2_f32_bf16 v35, v25, v14, v35
    s_waitcnt vmcnt(24)
    v_perm_b32 v22, v188, v184, s58
    v_perm_b32 v23, v188, v184, s59
    v_dot2_f32_bf16 v28, v22, v15, v28
    v_dot2_f32_bf16 v29, v23, v15, v29
    v_perm_b32 v24, v189, v185, s58
    v_perm_b32 v25, v189, v185, s59
    v_dot2_f32_bf16 v30, v24, v15, v30
    v_dot2_f32_bf16 v31, v25, v15, v31
    v_perm_b32 v22, v190, v186, s58
    v_perm_b32 v23, v190, v186, s59
    v_dot2_f32_bf16 v32, v22, v15, v32
    v_dot2_f32_bf16 v33, v23, v15, v33
    v_perm_b32 v24, v191, v187, s58
    v_perm_b32 v25, v191, v187, s59
    v_dot2_f32_bf16 v34, v24, v15, v34
    v_dot2_f32_bf16 v35, v25, v15, v35
    s_waitcnt vmcnt(22)
    v_perm_b32 v22, v196, v192, s58
    v_perm_b32 v23, v196, v192, s59
    v_dot2_f32_bf16 v28, v22, v16, v28
    v_dot2_f32_bf16 v29, v23, v16, v29
    v_perm_b32 v24, v197, v193, s58
    v_perm_b32 v25, v197, v193, s59
    v_dot2_f32_bf16 v30, v24, v16, v30
    v_dot2_f32_bf16 v31, v25, v16, v31
    v_perm_b32 v22, v198, v194, s58
    v_perm_b32 v23, v198, v194, s59
    v_dot2_f32_bf16 v32, v22, v16, v32
    v_dot2_f32_bf16 v33, v23, v16, v33
    v_perm_b32 v24, v199, v195, s58
    v_perm_b32 v25, v199, v195, s59
    v_dot2_f32_bf16 v34, v24, v16, v34
    v_dot2_f32_bf16 v35, v25, v16, v35
    s_waitcnt vmcnt(20)
    v_perm_b32 v22, v204, v200, s58
    v_perm_b32 v23, v204, v200, s59
    v_dot2_f32_bf16 v28, v22, v17, v28
    v_dot2_f32_bf16 v29, v23, v17, v29
    v_perm_b32 v24, v205, v201, s58
    v_perm_b32 v25, v205, v201, s59
    v_dot2_f32_bf16 v30, v24, v17, v30
    v_dot2_f32_bf16 v31, v25, v17, v31
    v_perm_b32 v22, v206, v202, s58
    v_perm_b32 v23, v206, v202, s59
    v_dot2_f32_bf16 v32, v22, v17, v32
    v_dot2_f32_bf16 v33, v23, v17, v33
    v_perm_b32 v24, v207, v203, s58
    v_perm_b32 v25, v207, v203, s59
    v_dot2_f32_bf16 v34, v24, v17, v34
    v_dot2_f32_bf16 v35, v25, v17, v35
    s_waitcnt vmcnt(18)
    v_perm_b32 v22, v212, v208, s58
    v_perm_b32 v23, v212, v208, s59
    v_dot2_f32_bf16 v28, v22, v18, v28
    v_dot2_f32_bf16 v29, v23, v18, v29
    v_perm_b32 v24, v213, v209, s58
    v_perm_b32 v25, v213, v209, s59
    v_dot2_f32_bf16 v30, v24, v18, v30
    v_dot2_f32_bf16 v31, v25, v18, v31
    v_perm_b32 v22, v214, v210, s58
    v_perm_b32 v23, v214, v210, s59
    v_dot2_f32_bf16 v32, v22, v18, v32
    v_dot2_f32_bf16 v33, v23, v18, v33
    v_perm_b32 v24, v215, v211, s58
    v_perm_b32 v25, v215, v211, s59
    v_dot2_f32_bf16 v34, v24, v18, v34
    v_dot2_f32_bf16 v35, v25, v18, v35
    s_waitcnt vmcnt(16)
    v_perm_b32 v22, v220, v216, s58
    v_perm_b32 v23, v220, v216, s59
    v_dot2_f32_bf16 v28, v22, v19, v28
    v_dot2_f32_bf16 v29, v23, v19, v29
    v_perm_b32 v24, v221, v217, s58
    v_perm_b32 v25, v221, v217, s59
    v_dot2_f32_bf16 v30, v24, v19, v30
    v_dot2_f32_bf16 v31, v25, v19, v31
    v_perm_b32 v22, v222, v218, s58
    v_perm_b32 v23, v222, v218, s59
    v_dot2_f32_bf16 v32, v22, v19, v32
    v_dot2_f32_bf16 v33, v23, v19, v33
    v_perm_b32 v24, v223, v219, s58
    v_perm_b32 v25, v223, v219, s59
    v_dot2_f32_bf16 v34, v24, v19, v34
    v_dot2_f32_bf16 v35, v25, v19, v35
    s_branch Lb1
Lnomod1:
    v_mov_b32 v49, 0
    v_mov_b32 v64, 0
    v_mov_b32 v68, 0
    v_lshlrev_b32 v232, 4, v0
    v_and_b32 v0, 63, v0
    v_lshlrev_b32 v1, 2, v0
    v_lshlrev_b32 v233, 4, v0
    v_and_b32 v2, 15, v0
    v_lshrrev_b32 v3, 4, v0
    s_lshl_b32 s37, s30, 8
    s_add_u32 s37, s37, s2
    s_mul_i32 s55, s37, 1280
    s_lshr_b32 s32, s30, 1
    s_and_b32 s33, s30, 1
    s_mov_b32 s58, 0x05040100
    s_mov_b32 s59, 0x07060302
    s_mov_b32 s36, 0x40004000
    s_and_b32 s48, s2, 7
    s_mul_i32 s39, s48, 105728
    s_add_u32 s39, s39, 524288
    s_lshr_b32 s49, s2, 6
    s_add_u32 s49, s49, 1
    s_cmp_lt_u32 s2, 128
    s_cselect_b32 s49, s49, 0
    s_bfe_u32 s50, s2, 0x30003
    s_sub_u32 s51, 0, s48
    s_and_b32 s51, s51, 7
    s_cmp_lt_u32 s50, 4
    s_cselect_b32 s51, s48, s51
    s_lshl_b32 s35, s49, 3
    s_add_u32 s35, s35, s51
    s_lshl_b32 s35, s35, 3
    s_add_u32 s35, s35, s50
    s_cmp_ge_u32 s30, 6
    s_cbranch_scc1 Lnoc1a
    v_lshrrev_b32 v120, 2, v2
    s_lshl_b32 s48, s33, 2
    v_add_u32 v120, s48, v120
    v_and_b32 v121, 3, v2
    v_mad_u32_u24 v121, v121, 5, s32
    v_cvt_f32_u32 v121, v121
    v_lshl_add_u32 v122, v3, 9, s2
    v_mul_u32_u24 v112, v120, v122
    v_lshl_add_u32 v113, v120, 8, v112
    v_and_b32 v112, 2047, v112
    v_and_b32 v113, 2047, v113
    v_cvt_f32_u32 v112, v112
    v_cvt_f32_u32 v113, v113
    v_mul_f32 v112, 0x3a000000, v112
    v_mul_f32 v113, 0x3a000000, v113
    v_mul_f32 v114, 0x3d4ccccd, v121
    v_cos_f32 v116, v112
    v_sin_f32 v118, v112
    v_fmamk_f32 v115, v114, 0x3f800000, v112
    v_cos_f32 v117, v115
    v_sin_f32 v119, v115
    v_cvt_pk_bf16_f32 v146, v116, v117
    v_cvt_pk_bf16_f32 v150, v118, v119
    v_cvt_pk_bf16_f32 v154, -v118, -v119
    v_fmamk_f32 v115, v114, 0x40000000, v112
    v_cos_f32 v116, v115
    v_sin_f32 v118, v115
    v_fmamk_f32 v115, v114, 0x40400000, v112
    v_cos_f32 v117, v115
    v_sin_f32 v119, v115
    v_cvt_pk_bf16_f32 v147, v116, v117
    v_cvt_pk_bf16_f32 v151, v118, v119
    v_cvt_pk_bf16_f32 v155, -v118, -v119
    v_cos_f32 v116, v113
    v_sin_f32 v118, v113
    v_fmamk_f32 v115, v114, 0x3f800000, v113
    v_cos_f32 v117, v115
    v_sin_f32 v119, v115
    v_cvt_pk_bf16_f32 v148, v116, v117
    v_cvt_pk_bf16_f32 v152, v118, v119
    v_cvt_pk_bf16_f32 v156, -v118, -v119
    v_fmamk_f32 v115, v114, 0x40000000, v113
    v_cos_f32 v116, v115
    v_sin_f32 v118, v115
    v_fmamk_f32 v115, v114, 0x40400000, v113
    v_cos_f32 v117, v115
    v_sin_f32 v119, v115
    v_cvt_pk_bf16_f32 v149, v116, v117
    v_cvt_pk_bf16_f32 v153, v118, v119
    v_cvt_pk_bf16_f32 v157, -v118, -v119
Lnoc1a:
    s_waitcnt lgkmcnt(0)
    s_load_dword s31, s[28:29], 0
    s_add_u32 s4, s4, s55
    s_addc_u32 s5, s5, 0
    s_mov_b64 s[26:27], s[24:25]
    s_add_u32 s24, s24, s55
    s_addc_u32 s25, s25, 0
    global_load_dword v4, v1, s[4:5] offset:0
    global_load_dword v5, v1, s[4:5] offset:256
    global_load_dword v6, v1, s[4:5] offset:512
    global_load_dword v7, v1, s[4:5] offset:768
    global_load_dword v8, v1, s[4:5] offset:1024
    s_cmp_lg_u32 s30, 6
    s_cbranch_scc1 Lwp0
    s_and_b32 s48, s2, 7
    s_and_b32 s49, s2, -8
    s_lshl_b32 s49, s49, 3
    s_add_u32 s48, s48, s49
    v_and_b32 v160, 56, v0
    v_add_u32 v160, s48, v160
    v_mul_u32_u24 v160, 642, v160
    v_and_b32 v161, 7, v0
    v_lshlrev_b32 v161, 7, v161
    v_min_u32 v161, 640, v161
    v_add_u32 v160, v160, v161
    v_and_b32 v160, -4, v160
    global_load_dword v162, v160, s[6:7]
    global_load_dword v163, v160, s[8:9]
Lwp0:
    s_cmp_ge_u32 s37, 16
    s_cbranch_scc1 Lnohi
    s_mul_i32 s48, s2, 6144
    s_add_u32 s48, s48, 327680
    v_mul_u32_u24 v124, 384, v0
    v_add_u32 v124, s48, v124
    v_mov_b32 v125, 0
    s_mov_b64 exec, 0xffff
    global_store_dword v124, v125, s[28:29] sc1
    s_mov_b64 exec, -1
Lnohi:
    s_cmp_ge_u32 s30, 6
    s_cbranch_scc1 Lnoc1b
    v_mul_f32 v112, 0x3acccccd, v121
    v_lshlrev_b32 v113, 2, v3
    v_cvt_f32_u32 v113, v113
    v_mul_f32 v114, v113, v112
    v_cos_f32 v190, v114
    v_sin_f32 v198, v114
    v_fmamk_f32 v115, v112, 0x3f800000, v114
    v_cos_f32 v191, v115
    v_sin_f32 v199, v115
    v_fmamk_f32 v115, v112, 0x40000000, v114
    v_cos_f32 v192, v115
    v_sin_f32 v200, v115
    v_fmamk_f32 v115, v112, 0x40400000, v114
    v_cos_f32 v193, v115
    v_sin_f32 v201, v115
    v_fmamk_f32 v115, v112, 0x41800000, v114
    v_cos_f32 v194, v115
    v_sin_f32 v202, v115
    v_fmamk_f32 v115, v112, 0x41880000, v114
    v_cos_f32 v195, v115
    v_sin_f32 v203, v115
    v_fmamk_f32 v115, v112, 0x41900000, v114
    v_cos_f32 v196, v115
    v_sin_f32 v204, v115
    v_fmamk_f32 v115, v112, 0x41980000, v114
    v_cos_f32 v197, v115
    v_sin_f32 v205, v115
    v_cvt_f32_u32 v112, v2
    v_mul_f32 v112, 0x3d000000, v112
    v_mul_f32 v114, v113, v112
    v_and_b32 v120, 1, v0
    v_mul_u32_u24 v120, 0x8000, v120
    v_lshl_or_b32 v120, v120, 16, v120
    v_cos_f32 v116, v114
    v_sin_f32 v117, v114
    s_nop 0
    v_cvt_pk_bf16_f32 v12, v116, v117
    v_cvt_pk_bf16_f32 v16, -v117, v116
    v_cvt_pk_bf16_f32 v20, v116, v117
    v_cvt_pk_bf16_f32 v24, -v117, v116
    v_fmamk_f32 v115, v112, 0x3f800000, v114
    v_cos_f32 v116, v115
    v_sin_f32 v117, v115
    s_nop 0
    v_cvt_pk_bf16_f32 v13, v116, v117
    v_cvt_pk_bf16_f32 v17, -v117, v116
    v_cvt_pk_bf16_f32 v21, -v116, -v117
    v_cvt_pk_bf16_f32 v25, v117, -v116
    v_fmamk_f32 v115, v112, 0x40000000, v114
    v_cos_f32 v116, v115
    v_sin_f32 v117, v115
    s_nop 0
    v_cvt_pk_bf16_f32 v14, v116, v117
    v_cvt_pk_bf16_f32 v18, -v117, v116
    v_cvt_pk_bf16_f32 v22, v116, v117
    v_cvt_pk_bf16_f32 v26, -v117, v116
    v_fmamk_f32 v115, v112, 0x40400000, v114
    v_cos_f32 v116, v115
    v_sin_f32 v117, v115
    s_nop 0
    v_cvt_pk_bf16_f32 v15, v116, v117
    v_cvt_pk_bf16_f32 v19, -v117, v116
    v_cvt_pk_bf16_f32 v23, -v116, -v117
    v_cvt_pk_bf16_f32 v27, v117, -v116
    v_xor_b32 v28, v120, v12
    v_xor_b32 v29, v120, v13
    v_xor_b32 v30, v120, v14
    v_xor_b32 v31, v120, v15
    v_xor_b32 v32, v120, v16
    v_xor_b32 v33, v120, v17
    v_xor_b32 v34, v120, v18
    v_xor_b32 v35, v120, v19
    v_xor_b32 v36, v120, v20
    v_xor_b32 v37, v120, v21
    v_xor_b32 v38, v120, v22
    v_xor_b32 v39, v120, v23
    v_xor_b32 v40, v120, v24
    v_xor_b32 v41, v120, v25
    v_xor_b32 v42, v120, v26
    v_xor_b32 v43, v120, v27
    v_cvt_f32_u32 v121, s32
    v_cvt_f32_u32 v112, v2
    v_mul_f32 v112, 0x3acccccd, v112
    v_add_f32 v113, 0x3ccccccd, v112
    v_mul_f32 v114, v121, v112
    v_cos_f32 v56, v114
    v_sin_f32 v64, v114
    v_fmamk_f32 v115, v112, 0x40a00000, v114
    v_cos_f32 v57, v115
    v_sin_f32 v65, v115
    v_fmamk_f32 v115, v112, 0x41200000, v114
    v_cos_f32 v58, v115
    v_sin_f32 v66, v115
    v_fmamk_f32 v115, v112, 0x41700000, v114
    v_cos_f32 v59, v115
    v_sin_f32 v67, v115
    v_mul_f32 v114, v121, v113
    v_cos_f32 v60, v114
    v_sin_f32 v68, v114
    v_fmamk_f32 v115, v113, 0x40a00000, v114
    v_cos_f32 v61, v115
    v_sin_f32 v69, v115
    v_fmamk_f32 v115, v113, 0x41200000, v114
    v_cos_f32 v62, v115
    v_sin_f32 v70, v115
    v_fmamk_f32 v115, v113, 0x41700000, v114
    v_cos_f32 v63, v115
    v_sin_f32 v71, v115
    v_lshrrev_b32 v114, 2, v2
    v_lshl_add_u32 v114, v114, 8, s2
    s_lshl_b32 s48, s33, 2
    v_add_u32 v112, s48, v3
    v_mul_u32_u24 v112, v112, v114
    v_and_b32 v112, 2047, v112
    v_cvt_f32_u32 v112, v112
    v_and_b32 v114, 3, v2
    v_cvt_f32_u32 v114, v114
    v_mul_f32 v114, 0x3d4ccccd, v114
    v_mul_f32 v115, v114, v121
    v_fmamk_f32 v112, v112, 0x3a000000, v115
    v_and_b32 v120, 1, v3
    v_mul_u32_u24 v120, 0x8000, v120
    v_lshl_or_b32 v120, v120, 16, v120
    v_cos_f32 v116, v112
    v_sin_f32 v118, v112
    v_fmamk_f32 v115, v114, 0x40a00000, v112
    v_cos_f32 v117, v115
    v_sin_f32 v119, v115
    s_nop 0
    v_cvt_pk_bf16_f32 v44, -v118, -v119
    v_cvt_pk_bf16_f32 v46, v116, v117
    v_cvt_pk_bf16_f32 v48, v118, v119
    v_fmamk_f32 v115, v114, 0x41200000, v112
    v_cos_f32 v116, v115
    v_sin_f32 v118, v115
    v_fmamk_f32 v115, v114, 0x41700000, v112
    v_cos_f32 v117, v115
    v_sin_f32 v119, v115
    s_nop 0
    v_cvt_pk_bf16_f32 v45, -v118, -v119
    v_cvt_pk_bf16_f32 v47, v116, v117
    v_cvt_pk_bf16_f32 v49, v118, v119
    v_xor_b32 v50, v120, v44
    v_xor_b32 v51, v120, v45
    v_xor_b32 v52, v120, v46
    v_xor_b32 v53, v120, v47
    v_xor_b32 v54, v120, v48
    v_xor_b32 v55, v120, v49
Lnoc1b:
    s_cmp_ge_u32 s2, 168
    s_cbranch_scc1 Lc2
    v_cvt_f32_u32 v112, v2
    v_mul_f32 v112, 0x3b800000, v112
    v_lshlrev_b32 v113, 6, v3
    s_lshl_b32 s48, s30, 1
    v_add_u32 v114, s48, v113
    v_cvt_f32_u32 v113, v113
    v_cvt_f32_u32 v114, v114
    v_mul_f32 v113, v113, v112
    v_mul_f32 v114, v114, v112
    v_cos_f32 v116, v114
    v_sin_f32 v117, v114
    s_nop 0
    v_cvt_pk_bf16_f32 v88, v116, v117
    v_cvt_pk_bf16_f32 v92, -v117, v116
    v_fmamk_f32 v115, v112, 0x41800000, v114
    v_cos_f32 v116, v115
    v_sin_f32 v117, v115
    s_nop 0
    v_cvt_pk_bf16_f32 v89, v116, v117
    v_cvt_pk_bf16_f32 v93, -v117, v116
    v_fmamk_f32 v115, v112, 0x42000000, v114
    v_cos_f32 v116, v115
    v_sin_f32 v117, v115
    s_nop 0
    v_cvt_pk_bf16_f32 v90, v116, v117
    v_cvt_pk_bf16_f32 v94, -v117, v116
    v_fmamk_f32 v115, v112, 0x42400000, v114
    v_cos_f32 v116, v115
    v_sin_f32 v117, v115
    s_nop 0
    v_cvt_pk_bf16_f32 v91, v116, v117
    v_cvt_pk_bf16_f32 v95, -v117, v116
    v_fmamk_f32 v115, v112, 0x3f800000, v114
    v_cos_f32 v116, v115
    v_sin_f32 v117, v115
    s_nop 0
    v_cvt_pk_bf16_f32 v96, v116, v117
    v_cvt_pk_bf16_f32 v100, -v117, v116
    v_fmamk_f32 v115, v112, 0x41880000, v114
    v_cos_f32 v116, v115
    v_sin_f32 v117, v115
    s_nop 0
    v_cvt_pk_bf16_f32 v97, v116, v117
    v_cvt_pk_bf16_f32 v101, -v117, v116
    v_fmamk_f32 v115, v112, 0x42040000, v114
    v_cos_f32 v116, v115
    v_sin_f32 v117, v115
    s_nop 0
    v_cvt_pk_bf16_f32 v98, v116, v117
    v_cvt_pk_bf16_f32 v102, -v117, v116
    v_fmamk_f32 v115, v112, 0x42440000, v114
    v_cos_f32 v116, v115
    v_sin_f32 v117, v115
    s_nop 0
    v_cvt_pk_bf16_f32 v99, v116, v117
    v_cvt_pk_bf16_f32 v103, -v117, v116
    v_cos_f32 v116, v113
    v_sin_f32 v117, v113
    s_nop 0
    v_cvt_pk_bf16_f32 v104, v116, v117
    v_cvt_pk_bf16_f32 v108, -v117, v116
    v_fmamk_f32 v115, v112, 0x41800000, v113
    v_cos_f32 v116, v115
    v_sin_f32 v117, v115
    s_nop 0
    v_cvt_pk_bf16_f32 v105, v116, v117
    v_cvt_pk_bf16_f32 v109, -v117, v116
    v_fmamk_f32 v115, v112, 0x42000000, v113
    v_cos_f32 v116, v115
    v_sin_f32 v117, v115
    s_nop 0
    v_cvt_pk_bf16_f32 v106, v116, v117
    v_cvt_pk_bf16_f32 v110, -v117, v116
    v_fmamk_f32 v115, v112, 0x42400000, v113
    v_cos_f32 v116, v115
    v_sin_f32 v117, v115
    s_nop 0
    v_cvt_pk_bf16_f32 v107, v116, v117
    v_cvt_pk_bf16_f32 v111, -v117, v116
Lc2:
    s_waitcnt lgkmcnt(0)
    s_lshl_b32 s48, s31, 16
    s_xor_b32 s31, s31, s48
    s_xor_b32 s31, s31, 0xffff
    v_mov_b32 v241, s31
    v_and_b32 v112, 3, v0
    v_lshl_add_u32 v113, v112, 2, 18
    v_alignbit_b32 v236, s31, s31, v113
    v_and_b32 v236, s36, v236
    v_add_u32 v113, 1, v113
    v_alignbit_b32 v237, s31, s31, v113
    v_and_b32 v237, s36, v237
    v_add_u32 v113, 1, v113
    v_alignbit_b32 v238, s31, s31, v113
    v_and_b32 v238, s36, v238
    v_add_u32 v113, 1, v113
    v_alignbit_b32 v239, s31, s31, v113
    v_and_b32 v239, s36, v239
    v_add_u32 v113, 18, v2
    v_alignbit_b32 v240, s31, s31, v113
    v_and_b32 v240, s36, v240
    s_cmp_ge_u32 s30, 5
    s_cbranch_scc1 Lwprep
    s_movk_i32 s48, 2560
    v_cmp_le_u32 s[10:11], s48, v232
    v_lshlrev_b32 v246, 1, v232
    v_mov_b32 v242, -5112
    v_cndmask_b32 v242, 0, v242, s[10:11]
    v_add_u32 v246, v242, v246
    s_add_u32 s48, s39, 0
    v_add_u32 v184, s48, v232
    s_add_u32 s48, s39, 15360
    v_add_u32 v185, s48, v232
    s_add_u32 s48, s39, 30720
    v_add_u32 v186, s48, v232
    s_add_u32 s48, s39, 46080
    v_add_u32 v187, s48, v232
    s_add_u32 s48, s39, 61440
    v_add_u32 v188, s48, v232
    v_mov_b32 v242, 0x00000000
    v_mov_b32 v243, 0x3f800000
    v_mov_b32 v244, 0x2b800000
    v_mov_b32 v245, 0x3f800000
    v_cndmask_b32 v242, v242, v243, s[10:11]
    v_cndmask_b32 v244, v244, v245, s[10:11]
    s_setprio 2
    v_mov_b32 v112, 100224
    s_mov_b32 s34, 100000
Lclk:
    ds_read_b32 v113, v112
    s_sub_u32 s34, s34, 1
    s_cbranch_scc1 Lclk_done
    s_waitcnt lgkmcnt(0)
    v_cmp_ne_u32 vcc, s31, v113
    s_cbranch_vccnz Lclk
Lclk_done:
    s_waitcnt lgkmcnt(0)
    global_load_dwordx4 v[160:163], v184, s[28:29] sc1
    global_load_dwordx4 v[164:167], v185, s[28:29] sc1
    global_load_dwordx4 v[168:171], v186, s[28:29] sc1
    global_load_dwordx4 v[172:175], v187, s[28:29] sc1
    global_load_dwordx4 v[176:179], v188, s[28:29] sc1
    v_mov_b32 v113, 1
    s_mov_b64 exec, 1
    ds_add_u32 v112, v113 offset:4
    s_mov_b64 exec, -1
    s_waitcnt vmcnt(5)
    v_lshlrev_b32 v132, 16, v4
    v_and_b32 v133, 0xffff0000, v4
    v_lshlrev_b32 v134, 16, v5
    v_and_b32 v135, 0xffff0000, v5
    v_lshlrev_b32 v136, 16, v6
    v_and_b32 v137, 0xffff0000, v6
    v_lshlrev_b32 v138, 16, v7
    v_and_b32 v139, 0xffff0000, v7
    v_lshlrev_b32 v140, 16, v8
    v_and_b32 v141, 0xffff0000, v8
    v_pk_add_f32 v[112:113], v[132:133], v[134:135]
    v_pk_mul_f32 v[114:115], v[132:133], v[132:133]
    v_pk_fma_f32 v[114:115], v[134:135], v[134:135], v[114:115]
    v_pk_add_f32 v[112:113], v[112:113], v[136:137]
    v_pk_fma_f32 v[114:115], v[136:137], v[136:137], v[114:115]
    v_pk_add_f32 v[112:113], v[112:113], v[138:139]
    v_pk_fma_f32 v[114:115], v[138:139], v[138:139], v[114:115]
    v_pk_add_f32 v[112:113], v[112:113], v[140:141]
    v_pk_fma_f32 v[114:115], v[140:141], v[140:141], v[114:115]
    v_add_f32 v112, v112, v113
    v_add_f32 v114, v114, v115
    s_nop 0
    v_add_f32_dpp v112, v112, v112 row_ror:8 row_mask:0xf bank_mask:0xf
    v_add_f32_dpp v114, v114, v114 row_ror:8 row_mask:0xf bank_mask:0xf
    s_nop 0
    v_add_f32_dpp v112, v112, v112 row_ror:4 row_mask:0xf bank_mask:0xf
    v_add_f32_dpp v114, v114, v114 row_ror:4 row_mask:0xf bank_mask:0xf
    s_nop 0
    v_add_f32_dpp v112, v112, v112 row_ror:2 row_mask:0xf bank_mask:0xf
    v_add_f32_dpp v114, v114, v114 row_ror:2 row_mask:0xf bank_mask:0xf
    s_nop 0
    v_add_f32_dpp v112, v112, v112 row_ror:1 row_mask:0xf bank_mask:0xf
    v_add_f32_dpp v114, v114, v114 row_ror:1 row_mask:0xf bank_mask:0xf
    s_nop 0
    v_add_f32_dpp v112, v112, v112 row_bcast:15 row_mask:0xa bank_mask:0xf
    v_add_f32_dpp v114, v114, v114 row_bcast:15 row_mask:0xa bank_mask:0xf
    s_nop 0
    v_add_f32_dpp v112, v112, v112 row_bcast:31 row_mask:0xc bank_mask:0xf
    v_add_f32_dpp v114, v114, v114 row_bcast:31 row_mask:0xc bank_mask:0xf
    v_readlane_b32 s48, v112, 63
    v_readlane_b32 s49, v114, 63
    v_mov_b32 v112, 0x3acccccd
    v_mul_f32 v113, s48, v112
    v_mul_f32 v114, s49, v112
    v_fma_f32 v114, -v113, v113, v114
    v_max_f32 v114, 0, v114
    v_add_f32 v114, 0x3727c5ac, v114
    v_rsq_f32 v114, v114
    s_nop 0
    v_mul_f32 v114, 0x2b800000, v114
    v_mul_f32_e64 v116, -v113, v114
    v_pk_fma_f32 v[132:133], v[132:133], v[114:115], v[116:117] op_sel_hi:[1,0,0]
    v_pk_fma_f32 v[134:135], v[134:135], v[114:115], v[116:117] op_sel_hi:[1,0,0]
    v_pk_fma_f32 v[136:137], v[136:137], v[114:115], v[116:117] op_sel_hi:[1,0,0]
    v_pk_fma_f32 v[138:139], v[138:139], v[114:115], v[116:117] op_sel_hi:[1,0,0]
    v_pk_fma_f32 v[140:141], v[140:141], v[114:115], v[116:117] op_sel_hi:[1,0,0]
    s_mul_i32 s48, s30, 272
    s_add_u32 s48, s48, 15360
    v_add_u32 v142, s48, v1
    s_mov_b32 s60, 0x3e9e377a
    s_mov_b32 s62, 0xbf4f1bbd
    s_mov_b32 s64, 0xbf737871
    s_mov_b32 s66, 0xbf167918
    v_mul_u32_u24 v144, 544, v3
    v_lshrrev_b32 v145, 2, v2
    v_lshl_add_u32 v144, v145, 6, v144
    v_and_b32 v145, 3, v2
    v_lshl_add_u32 v144, v145, 3, v144
    s_lshl_b32 s48, s32, 1
    s_max_u32 s48, s48, 1
    s_sub_u32 s48, s48, 1
    s_mul_i32 s48, s48, 2176
    s_add_u32 s48, s48, 15360
    v_add_u32 v144, s48, v144
    s_lshl_b32 s48, s30, 11
    s_mul_i32 s49, s2, 12544
    s_add_u32 s49, s48, s49
    s_add_u32 s49, s49, 2097152
    v_lshlrev_b32 v145, 9, v3
    v_lshl_add_u32 v145, v2, 4, v145
    s_add_u32 s42, s28, s49
    s_addc_u32 s43, s29, 0
    s_mul_i32 s49, s35, 16640
    s_add_u32 s48, s48, s49
    s_add_u32 s48, s48, 6291456
    s_add_u32 s44, s28, s48
    s_addc_u32 s45, s29, 0
    s_lshr_b32 s49, s35, 6
    s_and_b32 s50, s35, 7
    s_bfe_u32 s51, s35, 0x30003
    s_cmp_lt_u32 s50, 4
    s_cselect_b32 s52, 1, -1
    s_cselect_b32 s53, 0, 640
    s_lshl_b32 s50, s50, 4
    v_add_u32 v112, s50, v2
    v_mad_u32_u24 v112, v112, 5, s49
    v_mul_i32_i24 v112, s52, v112
    v_add_lshl_u32 v112, v112, s53, 1
    s_lshl_b32 s50, s30, 4
    s_add_u32 s50, s50, s51
    v_lshl_add_u32 v113, v3, 9, s50
    v_mul_i32_i24 v113, s52, v113
    s_movk_i32 s53, 642
    v_and_b32 v224, 2047, v113
    v_mad_u32_u24 v224, v224, s53, v112
    s_mul_i32 s48, s52, 128
    v_add_u32 v225, s48, v113
    v_and_b32 v225, 2047, v225
    v_mad_u32_u24 v225, v225, s53, v112
    s_mul_i32 s48, s52, 256
    v_add_u32 v226, s48, v113
    v_and_b32 v226, 2047, v226
    v_mad_u32_u24 v226, v226, s53, v112
    s_mul_i32 s48, s52, 384
    v_add_u32 v227, s48, v113
    v_and_b32 v227, 2047, v227
    v_mad_u32_u24 v227, v227, s53, v112
    s_mul_i32 s48, s52, 8
    v_add_u32 v228, s48, v113
    v_and_b32 v228, 2047, v228
    v_mad_u32_u24 v228, v228, s53, v112
    s_mul_i32 s48, s52, 136
    v_add_u32 v229, s48, v113
    v_and_b32 v229, 2047, v229
    v_mad_u32_u24 v229, v229, s53, v112
    s_mul_i32 s48, s52, 264
    v_add_u32 v230, s48, v113
    v_and_b32 v230, 2047, v230
    v_mad_u32_u24 v230, v230, s53, v112
    s_mul_i32 s48, s52, 392
    v_add_u32 v231, s48, v113
    v_and_b32 v231, 2047, v231
    v_mad_u32_u24 v231, v231, s53, v112
    s_and_b32 s48, s2, 7
    s_mul_i32 s48, s48, 384
    s_add_u32 s48, s48, 327680
    v_mul_u32_u24 v235, 6144, v0
    v_add_u32 v235, s48, v235
    s_cmp_eq_u32 s32, 0
    s_cselect_b32 s0, 0x00ff00ff, -1
    s_mov_b32 s1, s0
    s_mov_b32 s34, 100000
    s_bfe_u32 s48, s31, 0x80000
    s_bfe_u32 s49, s31, 0x80008
    s_bfe_u32 s50, s31, 0x80010
    s_bfe_u32 s51, s31, 0x80018
Lg1c_2:
    s_waitcnt vmcnt(4)
    v_xor_b32 v160, s48, v160
    v_xor_b32 v161, s49, v161
    v_xor_b32 v162, s50, v162
    v_xor_b32 v163, s51, v163
    v_or_b32 v180, v160, v161
    v_or3_b32 v180, v180, v162, v163
    s_waitcnt vmcnt(3)
    v_xor_b32 v164, s48, v164
    v_xor_b32 v165, s49, v165
    v_xor_b32 v166, s50, v166
    v_xor_b32 v167, s51, v167
    v_or3_b32 v180, v180, v164, v165
    v_or3_b32 v180, v180, v166, v167
    v_pk_add_f32 v[160:161], v[160:161], v[164:165]
    v_pk_add_f32 v[162:163], v[162:163], v[166:167]
    s_waitcnt vmcnt(2)
    v_xor_b32 v168, s48, v168
    v_xor_b32 v169, s49, v169
    v_xor_b32 v170, s50, v170
    v_xor_b32 v171, s51, v171
    v_or3_b32 v180, v180, v168, v169
    v_or3_b32 v180, v180, v170, v171
    v_pk_add_f32 v[160:161], v[160:161], v[168:169]
    v_pk_add_f32 v[162:163], v[162:163], v[170:171]
    s_waitcnt vmcnt(1)
    v_xor_b32 v172, s48, v172
    v_xor_b32 v173, s49, v173
    v_xor_b32 v174, s50, v174
    v_xor_b32 v175, s51, v175
    v_or3_b32 v180, v180, v172, v173
    v_or3_b32 v180, v180, v174, v175
    v_pk_add_f32 v[160:161], v[160:161], v[172:173]
    v_pk_add_f32 v[162:163], v[162:163], v[174:175]
    s_waitcnt vmcnt(0)
    v_xor_b32 v176, s48, v176
    v_xor_b32 v177, s49, v177
    v_xor_b32 v178, s50, v178
    v_xor_b32 v179, s51, v179
    v_or3_b32 v180, v180, v176, v177
    v_or3_b32 v180, v180, v178, v179
    v_pk_add_f32 v[160:161], v[160:161], v[176:177]
    v_pk_add_f32 v[162:163], v[162:163], v[178:179]
    v_and_b32 v180, 0xff, v180
    v_cmp_ne_u32 vcc, 0, v180
    s_cbranch_vccnz Lg1r_1
Lg1d_3:
    s_mov_b64 exec, -1
    v_cvt_pk_bf16_f32 v164, v160, v161
    v_cvt_pk_bf16_f32 v166, v162, v163
    v_lshlrev_b32 v160, 16, v164
    v_and_b32 v161, 0xffff0000, v164
    v_lshlrev_b32 v162, 16, v166
    v_and_b32 v163, 0xffff0000, v166
    v_pk_add_f32 v[160:161], v[160:161], v[242:243] op_sel_hi:[1,0]
    v_pk_add_f32 v[162:163], v[162:163], v[242:243] op_sel_hi:[1,0]
    v_cvt_pk_bf16_f32 v164, v160, v161
    v_cvt_pk_bf16_f32 v166, v162, v163
    v_lshlrev_b32 v160, 16, v164
    v_and_b32 v161, 0xffff0000, v164
    v_lshlrev_b32 v162, 16, v166
    v_and_b32 v163, 0xffff0000, v166
    ds_write_b64 v246, v[160:161] offset:0
    ds_write_b64 v246, v[162:163] offset:16
Lb1:
    s_setprio 2
    s_waitcnt lgkmcnt(0)
    s_barrier
    ds_read_b128 v[112:115], v233 offset:0
    ds_read_b128 v[116:119], v233 offset:1024
    ds_read_b128 v[120:123], v233 offset:2048
    ds_read_b128 v[124:127], v233 offset:3072
    ds_read_b128 v[128:131], v233 offset:4096
    s_cmp_lg_u32 s30, 6
    s_cbranch_scc1 Lb1x
    s_mov_b32 exec_hi, 0x0fffffff
    global_load_dword v66, v64, s[14:15]
    s_mov_b64 exec, -1
    s_mov_b32 exec_lo, 0x7fff
    s_mov_b32 exec_hi, 0x0
    global_load_dword v69, v68, s[16:17]
    s_mov_b64 exec, -1
Lb1x:
    s_waitcnt lgkmcnt(4)
    v_pk_fma_f32 v[132:133], v[132:133], v[114:115], v[112:113]
    s_waitcnt lgkmcnt(3)
    v_pk_fma_f32 v[134:135], v[134:135], v[118:119], v[116:117]
    s_waitcnt lgkmcnt(2)
    v_pk_fma_f32 v[136:137], v[136:137], v[122:123], v[120:121]
    s_waitcnt lgkmcnt(1)
    v_pk_fma_f32 v[138:139], v[138:139], v[126:127], v[124:125]
    s_waitcnt lgkmcnt(0)
    v_pk_fma_f32 v[140:141], v[140:141], v[130:131], v[128:129]
    v_pk_add_f32 v[112:113], v[134:135], v[140:141]
    v_pk_add_f32 v[114:115], v[136:137], v[138:139]
    v_pk_add_f32 v[116:117], v[134:135], v[140:141] neg_lo:[0,1] neg_hi:[0,1]
    v_pk_add_f32 v[118:119], v[136:137], v[138:139] neg_lo:[0,1] neg_hi:[0,1]
    v_pk_fma_f32 v[134:135], v[112:113], s[60:61], v[132:133] op_sel_hi:[1,0,1]
    v_pk_fma_f32 v[138:139], v[112:113], s[62:63], v[132:133] op_sel_hi:[1,0,1]
    v_pk_add_f32 v[132:133], v[132:133], v[112:113]
    v_pk_mul_f32 v[136:137], v[116:117], s[64:65] op_sel_hi:[1,0]
    v_pk_mul_f32 v[140:141], v[116:117], s[66:67] op_sel_hi:[1,0]
    v_pk_fma_f32 v[134:135], v[114:115], s[62:63], v[134:135] op_sel_hi:[1,0,1]
    v_pk_fma_f32 v[138:139], v[114:115], s[60:61], v[138:139] op_sel_hi:[1,0,1]
    v_pk_add_f32 v[132:133], v[132:133], v[114:115]
    v_pk_fma_f32 v[136:137], v[118:119], s[66:67], v[136:137] op_sel_hi:[1,0,1]
    v_pk_fma_f32 v[140:141], v[118:119], s[64:65], v[140:141] op_sel_hi:[1,0,1] neg_lo:[1,0,0] neg_hi:[1,0,0]
    v_cvt_pk_bf16_f32 v120, v132, v133
    ds_write_b32 v142, v120 offset:0
    v_cvt_pk_bf16_f32 v121, v134, v135
    ds_write_b32 v142, v121 offset:2176
    v_cvt_pk_bf16_f32 v122, v136, v137
    ds_write_b32 v142, v122 offset:4352
    v_cvt_pk_bf16_f32 v123, v138, v139
    ds_write_b32 v142, v123 offset:6528
    v_cvt_pk_bf16_f32 v124, v140, v141
    ds_write_b32 v142, v124 offset:8704
    s_waitcnt lgkmcnt(0)
    s_barrier
    s_cmp_ge_u32 s30, 6
    s_cbranch_scc1 Lp1_idle
    ds_read_b64_tr_b16 v[112:113], v144 offset:0
    ds_read_b64_tr_b16 v[114:115], v144 offset:272
    ds_read_b64_tr_b16 v[116:117], v144 offset:32
    ds_read_b64_tr_b16 v[118:119], v144 offset:304
    ds_read_b64_tr_b16 v[120:121], v144 offset:2176
    ds_read_b64_tr_b16 v[122:123], v144 offset:2448
    ds_read_b64_tr_b16 v[124:125], v144 offset:2208
    ds_read_b64_tr_b16 v[126:127], v144 offset:2480
    s_waitcnt lgkmcnt(6)
    v_mfma_f32_16x16x32_bf16 v[128:131], v[112:115], v[146:149], 0
    v_mfma_f32_16x16x32_bf16 v[136:139], v[112:115], v[154:157], 0
    s_waitcnt lgkmcnt(4)
    v_mfma_f32_16x16x32_bf16 v[132:135], v[116:119], v[146:149], 0
    v_mfma_f32_16x16x32_bf16 v[140:143], v[116:119], v[154:157], 0
    s_cmp_eq_u32 s32, 0
    s_cbranch_scc1 Lp1_tw
    s_waitcnt lgkmcnt(2)
    v_mfma_f32_16x16x32_bf16 v[128:131], v[120:123], v[150:153], v[128:131]
    v_mfma_f32_16x16x32_bf16 v[136:139], v[120:123], v[146:149], v[136:139]
    s_waitcnt lgkmcnt(0)
    v_mfma_f32_16x16x32_bf16 v[132:135], v[124:127], v[150:153], v[132:135]
    v_mfma_f32_16x16x32_bf16 v[140:143], v[124:127], v[146:149], v[140:143]
Lp1_tw:
    s_waitcnt lgkmcnt(0)
    s_nop 3
    v_pk_mul_f32 v[120:121], v[136:137], v[198:199]
    v_pk_mul_f32 v[136:137], v[136:137], v[190:191]
    v_pk_mul_f32 v[122:123], v[138:139], v[200:201]
    v_pk_mul_f32 v[138:139], v[138:139], v[192:193]
    v_pk_fma_f32 v[136:137], v[128:129], v[198:199], v[136:137] neg_lo:[1,0,0] neg_hi:[1,0,0]
    v_pk_fma_f32 v[128:129], v[128:129], v[190:191], v[120:121]
    v_pk_fma_f32 v[138:139], v[130:131], v[200:201], v[138:139] neg_lo:[1,0,0] neg_hi:[1,0,0]
    v_pk_fma_f32 v[130:131], v[130:131], v[192:193], v[122:123]
    v_cvt_pk_bf16_f32 v112, v128, v136
    v_cvt_pk_bf16_f32 v113, v129, v137
    v_cvt_pk_bf16_f32 v114, v130, v138
    v_cvt_pk_bf16_f32 v115, v131, v139
    s_nop 1
    v_mfma_f32_16x16x32_bf16 v[208:211], v[112:115], v[12:15], 0
    v_mfma_f32_16x16x32_bf16 v[216:219], v[112:115], v[16:19], 0
    v_mfma_f32_16x16x32_bf16 v[212:215], v[112:115], v[20:23], 0
    v_mfma_f32_16x16x32_bf16 v[220:223], v[112:115], v[24:27], 0
    v_pk_mul_f32 v[120:121], v[140:141], v[202:203]
    v_pk_mul_f32 v[140:141], v[140:141], v[194:195]
    v_pk_mul_f32 v[122:123], v[142:143], v[204:205]
    v_pk_mul_f32 v[142:143], v[142:143], v[196:197]
    v_pk_fma_f32 v[140:141], v[132:133], v[202:203], v[140:141] neg_lo:[1,0,0] neg_hi:[1,0,0]
    v_pk_fma_f32 v[132:133], v[132:133], v[194:195], v[120:121]
    v_pk_fma_f32 v[142:143], v[134:135], v[204:205], v[142:143] neg_lo:[1,0,0] neg_hi:[1,0,0]
    v_pk_fma_f32 v[134:135], v[134:135], v[196:197], v[122:123]
    v_cvt_pk_bf16_f32 v116, v132, v140
    v_cvt_pk_bf16_f32 v117, v133, v141
    v_cvt_pk_bf16_f32 v118, v134, v142
    v_cvt_pk_bf16_f32 v119, v135, v143
    s_nop 1
    v_mfma_f32_16x16x32_bf16 v[208:211], v[116:119], v[28:31], v[208:211]
    v_mfma_f32_16x16x32_bf16 v[216:219], v[116:119], v[32:35], v[216:219]
    v_mfma_f32_16x16x32_bf16 v[212:215], v[116:119], v[36:39], v[212:215]
    v_mfma_f32_16x16x32_bf16 v[220:223], v[116:119], v[40:43], v[220:223]
    s_nop 5
    v_cvt_pk_bf16_f32 v120, v208, v216
    v_cvt_pk_bf16_f32 v121, v209, v217
    v_cvt_pk_bf16_f32 v122, v210, v218
    v_cvt_pk_bf16_f32 v123, v211, v219
    v_xor_b32 v120, v236, v120
    v_xor_b32 v121, v237, v121
    v_xor_b32 v122, v238, v122
    v_xor_b32 v123, v239, v123
    global_store_dwordx4 v145, v[120:123], s[42:43] offset:0 sc1
    v_cvt_pk_bf16_f32 v124, v212, v220
    v_cvt_pk_bf16_f32 v125, v213, v221
    v_cvt_pk_bf16_f32 v126, v214, v222
    v_cvt_pk_bf16_f32 v127, v215, v223
    v_xor_b32 v124, v236, v124
    v_xor_b32 v125, v237, v125
    v_xor_b32 v126, v238, v126
    v_xor_b32 v127, v239, v127
    s_mov_b64 exec, s[0:1]
    global_store_dwordx4 v145, v[124:127], s[42:43] offset:256 sc1
    s_mov_b64 exec, -1
    s_setprio 0
    s_cmp_ge_u32 s2, 168
    s_cbranch_scc1 Lidle2
    global_load_dword v247, v1, s[12:13] offset:0
    global_load_dword v248, v1, s[12:13] offset:256
    global_load_dword v249, v1, s[12:13] offset:512
    global_load_dword v250, v1, s[12:13] offset:768
    global_load_dword v251, v1, s[12:13] offset:1024
Lp1_done:
    s_lshl_b32 s48, s35, 6
    s_mul_i32 s49, s30, 25088
    s_add_u32 s48, s48, s49
    s_add_u32 s48, s48, 2097152
    v_mul_u32_u24 v160, 802816, v3
    v_lshl_add_u32 v160, v2, 2, v160
    s_add_u32 s40, s28, s48
    s_addc_u32 s41, s29, 0
    s_add_u32 s46, s40, 12544
    s_addc_u32 s47, s41, 0
    v_add_u32 v161, 200704, v160
    v_add_u32 v162, 401408, v160
    v_add_u32 v163, 602112, v160
    v_lshrrev_b32 v164, 2, v2
    v_sub_u32 v164, 0, v164
    v_and_b32 v164, 3, v164
    v_xor_b32 v165, v164, v3
    v_lshlrev_b32 v165, 4, v165
    v_lshl_add_u32 v165, v2, 6, v165
    s_mul_i32 s48, s30, 2048
    s_add_u32 s48, s48, 26368
    v_add_u32 v165, s48, v165
    v_xor_b32 v164, s32, v164
    v_lshlrev_b32 v164, 4, v164
    v_lshl_add_u32 v164, v2, 6, v164
    v_lshl_add_u32 v164, v3, 12, v164
    s_lshl_b32 s48, s33, 3
    s_add_u32 s48, s48, 26368
    v_add_u32 v164, s48, v164
    s_barrier
    s_sub_u32 s48, s30, 5
    s_cmp_lt_u32 s48, 3
    s_cbranch_scc1 Lnog
    global_load_ushort v72, v224, s[6:7]
    global_load_ushort v80, v224, s[8:9]
    global_load_ushort v73, v225, s[6:7]
    global_load_ushort v81, v225, s[8:9]
    global_load_ushort v74, v226, s[6:7]
    global_load_ushort v82, v226, s[8:9]
    global_load_ushort v75, v227, s[6:7]
    global_load_ushort v83, v227, s[8:9]
    global_load_ushort v76, v228, s[6:7]
    global_load_ushort v84, v228, s[8:9]
    global_load_ushort v77, v229, s[6:7]
    global_load_ushort v85, v229, s[8:9]
    global_load_ushort v78, v230, s[6:7]
    global_load_ushort v86, v230, s[8:9]
    global_load_ushort v79, v231, s[6:7]
    global_load_ushort v87, v231, s[8:9]
Lnog:
    s_cmp_ge_u32 s30, 5
    s_cbranch_scc1 Lb3w
    s_waitcnt vmcnt(21)
Lb3:
    s_setprio 2
    s_barrier
    global_load_dword v112, v160, s[40:41] sc1
    global_load_dword v113, v161, s[40:41] sc1
    global_load_dword v114, v162, s[40:41] sc1
    global_load_dword v115, v163, s[40:41] sc1
    global_load_dword v116, v160, s[46:47] sc1
    global_load_dword v117, v161, s[46:47] sc1
    global_load_dword v118, v162, s[46:47] sc1
    global_load_dword v119, v163, s[46:47] sc1
    s_setprio 0
    s_cmp_ge_u32 s30, 6
    s_cbranch_scc1 Lnc3
Lnc3:
    s_setprio 2
    s_and_b32 s48, s35, 7
    s_cmp_lt_u32 s48, 4
    s_cselect_b32 s49, 0, 0x8000
    s_cselect_b32 s50, 0x2c00, 0
    s_cmp_lt_u32 s35, 64
    s_cselect_b32 s50, s50, 0x2b80
    s_and_b32 s48, s48, 3
    s_cselect_b32 s51, s50, 0x2b80
    v_mov_b32 v168, s50
    v_mov_b32 v169, s51
    v_cmp_eq_u32 vcc, 0, v2
    s_nop 1
    v_cndmask_b32 v168, v168, v169, vcc
    v_xor_b32 v169, s49, v168
    s_waitcnt vmcnt(8)
    v_dot2_f32_bf16 v72, v72, v168, 0
    v_dot2_f32_bf16 v80, v80, v169, 0
    v_dot2_f32_bf16 v73, v73, v168, 0
    v_dot2_f32_bf16 v81, v81, v169, 0
    v_dot2_f32_bf16 v74, v74, v168, 0
    v_dot2_f32_bf16 v82, v82, v169, 0
    v_dot2_f32_bf16 v75, v75, v168, 0
    v_dot2_f32_bf16 v83, v83, v169, 0
    v_dot2_f32_bf16 v76, v76, v168, 0
    v_dot2_f32_bf16 v84, v84, v169, 0
    v_dot2_f32_bf16 v77, v77, v168, 0
    v_dot2_f32_bf16 v85, v85, v169, 0
    v_dot2_f32_bf16 v78, v78, v168, 0
    v_dot2_f32_bf16 v86, v86, v169, 0
    v_dot2_f32_bf16 v79, v79, v168, 0
    v_dot2_f32_bf16 v87, v87, v169, 0
    s_mov_b32 s34, 100000
Lz1c_5:
    s_waitcnt vmcnt(4)
    v_xor_b32 v112, v240, v112
    v_xor_b32 v113, v240, v113
    v_xor_b32 v114, v240, v114
    v_xor_b32 v115, v240, v115
    s_nop 1
    v_mfma_f32_16x16x32_bf16 v[120:123], v[88:91], v[112:115], 0
    v_mfma_f32_16x16x32_bf16 v[128:131], v[92:95], v[112:115], 0
    s_waitcnt vmcnt(0)
    v_xor_b32 v116, v240, v116
    v_xor_b32 v117, v240, v117
    v_xor_b32 v118, v240, v118
    v_xor_b32 v119, v240, v119
    s_nop 1
    v_mfma_f32_16x16x32_bf16 v[124:127], v[96:99], v[116:119], 0
    v_mfma_f32_16x16x32_bf16 v[132:135], v[100:103], v[116:119], 0
    v_or3_b32 v136, v112, v113, v114
    v_or3_b32 v136, v136, v115, v116
    v_or3_b32 v136, v136, v117, v118
    v_or_b32 v136, v136, v119
    v_and_b32 v136, s36, v136
    v_cmp_ne_u32 vcc, 0, v136
    s_cbranch_vccnz Lz1r_4
Lz1d_6:
    v_cvt_pk_bf16_f32 v136, v120, v128
    v_cvt_pk_bf16_f32 v138, v121, v129
    v_cvt_pk_bf16_f32 v140, v122, v130
    v_cvt_pk_bf16_f32 v142, v123, v131
    v_cvt_pk_bf16_f32 v137, v124, v132
    ds_write_b64 v164, v[136:137] offset:0
    v_cvt_pk_bf16_f32 v139, v125, v133
    ds_write_b64 v164, v[138:139] offset:1024
    v_cvt_pk_bf16_f32 v141, v126, v134
    ds_write_b64 v164, v[140:141] offset:2048
    v_cvt_pk_bf16_f32 v143, v127, v135
    ds_write_b64 v164, v[142:143] offset:3072
    s_waitcnt lgkmcnt(0)
    s_barrier
    ds_read_b128 v[112:115], v165 offset:0
    ds_read_b128 v[116:119], v165 offset:1024
    s_cmp_lg_u32 s30, 7
    s_cbranch_scc1 Lnocan_7
    s_cmp_lt_u32 s2, 80
    s_cbranch_scc1 Lnocan_7
    s_sub_u32 s48, s2, 112
    s_cmp_lt_u32 s48, 48
    s_cbranch_scc1 Lnocan_7
    s_lshl_b32 s48, s2, 7
    s_add_u32 s48, s48, -6144
    v_mov_b32 v160, s48
    v_mov_b32 v161, s31
    s_mov_b64 exec, 1
    global_store_dword v160, v161, s[28:29] sc1
    s_mov_b64 exec, -1
Lnocan_7:
    s_waitcnt lgkmcnt(1)
    v_mfma_f32_16x16x32_bf16 v[120:123], v[104:107], v[112:115], 0
    v_mfma_f32_16x16x32_bf16 v[128:131], v[108:111], v[112:115], 0
    s_waitcnt lgkmcnt(0)
    v_mfma_f32_16x16x32_bf16 v[124:127], v[104:107], v[116:119], 0
    v_mfma_f32_16x16x32_bf16 v[132:135], v[108:111], v[116:119], 0
    s_nop 4
    v_pk_mul_f32 v[136:137], v[128:129], v[80:81]
    v_pk_mul_f32 v[128:129], v[128:129], v[72:73]
    v_pk_mul_f32 v[138:139], v[130:131], v[82:83]
    v_pk_mul_f32 v[130:131], v[130:131], v[74:75]
    v_pk_fma_f32 v[128:129], v[120:121], v[80:81], v[128:129]
    v_pk_fma_f32 v[120:121], v[120:121], v[72:73], v[136:137] neg_lo:[0,0,1] neg_hi:[0,0,1]
    v_pk_fma_f32 v[130:131], v[122:123], v[82:83], v[130:131]
    v_pk_fma_f32 v[122:123], v[122:123], v[74:75], v[138:139] neg_lo:[0,0,1] neg_hi:[0,0,1]
    v_cvt_pk_bf16_f32 v112, v120, -v128
    v_cvt_pk_bf16_f32 v113, v121, -v129
    v_cvt_pk_bf16_f32 v114, v122, -v130
    v_cvt_pk_bf16_f32 v115, v123, -v131
    s_nop 1
    v_mfma_f32_16x16x32_bf16 v[120:123], v[88:91], v[112:115], 0
    v_mfma_f32_16x16x32_bf16 v[128:131], v[92:95], v[112:115], 0
    v_pk_mul_f32 v[136:137], v[132:133], v[84:85]
    v_pk_mul_f32 v[132:133], v[132:133], v[76:77]
    v_pk_mul_f32 v[138:139], v[134:135], v[86:87]
    v_pk_mul_f32 v[134:135], v[134:135], v[78:79]
    v_pk_fma_f32 v[132:133], v[124:125], v[84:85], v[132:133]
    v_pk_fma_f32 v[124:125], v[124:125], v[76:77], v[136:137] neg_lo:[0,0,1] neg_hi:[0,0,1]
    v_pk_fma_f32 v[134:135], v[126:127], v[86:87], v[134:135]
    v_pk_fma_f32 v[126:127], v[126:127], v[78:79], v[138:139] neg_lo:[0,0,1] neg_hi:[0,0,1]
    v_cvt_pk_bf16_f32 v116, v124, -v132
    v_cvt_pk_bf16_f32 v117, v125, -v133
    v_cvt_pk_bf16_f32 v118, v126, -v134
    v_cvt_pk_bf16_f32 v119, v127, -v135
    s_nop 1
    v_mfma_f32_16x16x32_bf16 v[124:127], v[96:99], v[116:119], 0
    v_mfma_f32_16x16x32_bf16 v[132:135], v[100:103], v[116:119], 0
    s_cmp_lg_u32 s30, 6
    s_cbranch_scc1 Lha_8
    v_mov_b32 v160, 1
    s_mov_b64 exec, 0xffff
    global_atomic_add v235, v160, s[28:29] offset:3072 sc1
    s_mov_b64 exec, -1
Lha_8:
    v_cvt_pk_bf16_f32 v136, v120, v128
    v_cvt_pk_bf16_f32 v138, v121, v129
    v_cvt_pk_bf16_f32 v140, v122, v130
    v_cvt_pk_bf16_f32 v142, v123, v131
    s_nop 1
    v_cvt_pk_bf16_f32 v137, v124, v132
    ds_write_b64 v164, v[136:137] offset:16384
    v_cvt_pk_bf16_f32 v139, v125, v133
    ds_write_b64 v164, v[138:139] offset:17408
    v_cvt_pk_bf16_f32 v141, v126, v134
    ds_write_b64 v164, v[140:141] offset:18432
    v_cvt_pk_bf16_f32 v143, v127, v135
    ds_write_b64 v164, v[142:143] offset:19456
    s_waitcnt lgkmcnt(0)
    s_barrier
    ds_read_b128 v[112:115], v165 offset:16384
    ds_read_b128 v[116:119], v165 offset:17408
    s_waitcnt lgkmcnt(1)
    v_mfma_f32_16x16x32_bf16 v[120:123], v[104:107], v[112:115], 0
    v_mfma_f32_16x16x32_bf16 v[128:131], v[108:111], v[112:115], 0
    s_waitcnt lgkmcnt(0)
    v_mfma_f32_16x16x32_bf16 v[124:127], v[104:107], v[116:119], 0
    v_mfma_f32_16x16x32_bf16 v[132:135], v[108:111], v[116:119], 0
    s_nop 4
    v_cvt_pk_bf16_f32 v136, v120, v128
    v_cvt_pk_bf16_f32 v137, v121, v129
    v_cvt_pk_bf16_f32 v138, v122, v130
    v_cvt_pk_bf16_f32 v139, v123, v131
    v_mov_b64 v[112:113], v[136:137]
    v_cvt_pk_bf16_f32 v140, v124, v132
    v_cvt_pk_bf16_f32 v141, v125, v133
    v_cvt_pk_bf16_f32 v142, v126, v134
    v_cvt_pk_bf16_f32 v143, v127, v135
    v_mov_b64 v[114:115], v[140:141]
    v_mov_b32_dpp v136, v138 row_ror:8 row_mask:0xf bank_mask:0xc
    v_mov_b32_dpp v137, v139 row_ror:8 row_mask:0xf bank_mask:0xc
    v_mov_b32_dpp v140, v142 row_ror:8 row_mask:0xf bank_mask:0xc
    v_mov_b32_dpp v141, v143 row_ror:8 row_mask:0xf bank_mask:0xc
    v_mov_b32_dpp v138, v112 row_ror:8 row_mask:0xf bank_mask:0x3
    v_mov_b32_dpp v139, v113 row_ror:8 row_mask:0xf bank_mask:0x3
    v_mov_b32_dpp v142, v114 row_ror:8 row_mask:0xf bank_mask:0x3
    v_mov_b32_dpp v143, v115 row_ror:8 row_mask:0xf bank_mask:0x3
    v_xor_b32 v72, v236, v136
    v_xor_b32 v73, v237, v137
    v_xor_b32 v74, v238, v138
    v_xor_b32 v75, v239, v139
    v_xor_b32_dpp v72, v137, v236 row_shr:4 row_mask:0xf bank_mask:0xa
    v_xor_b32_dpp v73, v136, v237 row_shl:4 row_mask:0xf bank_mask:0x5
    v_xor_b32_dpp v74, v139, v238 row_shr:4 row_mask:0xf bank_mask:0xa
    v_xor_b32_dpp v75, v138, v239 row_shl:4 row_mask:0xf bank_mask:0x5
    global_store_dwordx4 v233, v[72:75], s[44:45] offset:0 sc1
    v_xor_b32 v76, v236, v140
    v_xor_b32 v77, v237, v141
    v_xor_b32 v78, v238, v142
    v_xor_b32 v79, v239, v143
    v_xor_b32_dpp v76, v141, v236 row_shr:4 row_mask:0xf bank_mask:0xa
    v_xor_b32_dpp v77, v140, v237 row_shl:4 row_mask:0xf bank_mask:0x5
    v_xor_b32_dpp v78, v143, v238 row_shr:4 row_mask:0xf bank_mask:0xa
    v_xor_b32_dpp v79, v142, v239 row_shl:4 row_mask:0xf bank_mask:0x5
    global_store_dwordx4 v233, v[76:79], s[44:45] offset:1024 sc1
    s_setprio 0
    s_add_u32 s49, s39, 87552
    v_add_u32 v100, s49, v232
    s_cmp_ge_u32 s30, 5
    s_cbranch_scc1 Lfl1
    global_load_dwordx4 v[88:91], v100, s[28:29] offset:-2560 sc1
    global_load_dwordx4 v[92:95], v100, s[28:29] offset:2560 sc1
Lfl1:
Lp2_done:
    s_lshl_b32 s48, s33, 2
    v_add_lshl_u32 v147, v3, s48, 4
    v_lshlrev_b32 v132, 3, v0
    v_xor_b32 v147, v147, v132
    s_mul_i32 s48, s30, 512
    s_add_u32 s48, s48, 59136
    v_add_u32 v147, s48, v147
    s_mov_b32 s60, 0x3f1e377a
    s_mov_b32 s62, 0xbfcf1bbd
    s_mov_b32 s64, 0x3ff37871
    s_mov_b32 s66, 0x3f967918
    s_and_b32 s48, s2, 15
    s_lshl_b32 s48, s48, 4
    s_lshr_b32 s49, s2, 4
    s_add_u32 s48, s48, s49
    s_lshl_b32 s48, s48, 6
    s_mul_i32 s49, s30, 532480
    s_add_u32 s48, s48, s49
    s_add_u32 s48, s48, 6291456
    s_add_u32 s4, s28, s48
    s_addc_u32 s5, s29, 0
    s_add_u32 s20, s4, 66560
    s_addc_u32 s21, s5, 0
    v_lshrrev_b32 v159, 2, v2
    v_lshl_add_u32 v158, v159, 3, v3
    v_mul_u32_u24 v158, 16640, v158
    v_and_b32 v132, 3, v2
    v_lshl_add_u32 v158, v132, 4, v158
    v_and_b32 v159, 7, v0
    v_xor_b32 v159, v159, v3
    v_lshlrev_b32 v159, 4, v159
    v_lshl_add_u32 v159, v2, 7, v159
    s_lshl_b32 s48, s32, 1
    s_max_u32 s48, s48, 1
    s_sub_u32 s48, s48, 1
    s_mul_i32 s48, s48, 4096
    s_mul_i32 s49, s33, 20480
    s_add_u32 s48, s48, s49
    s_add_u32 s48, s48, 59136
    v_add_u32 v159, s48, v159
    v_xor_b32 v146, 64, v159
    s_cmp_eq_u32 s32, 0
    s_cselect_b64 s[0:1], 0xffff, -1
    v_lshlrev_b32 v148, 16, v247
    v_and_b32 v149, 0xffff0000, v247
    v_lshlrev_b32 v150, 16, v248
    v_and_b32 v151, 0xffff0000, v248
    v_lshlrev_b32 v152, 16, v249
    v_and_b32 v153, 0xffff0000, v249
    v_lshlrev_b32 v154, 16, v250
    v_and_b32 v155, 0xffff0000, v250
    v_lshlrev_b32 v156, 16, v251
    v_and_b32 v157, 0xffff0000, v251
    v_mov_b32 v252, 0x3acccccd
    v_mov_b32 v253, 0x3727c5ac
    v_mov_b32 v254, 0x7f7ff800
    v_mov_b32 v255, 0x7ff
    s_lshl_b32 s48, s30, 2
    s_add_u32 s48, s48, 100096
    v_mov_b32 v9, s48
    v_and_b32 v10, 28, v1
    v_add_u32 v10, 100096, v10
    s_lshl_b32 s48, s2, 3
    s_add_u32 s48, s48, 16384
    v_mul_u32_u24 v11, 2304, v0
    v_add_u32 v11, s48, v11
    s_lshl_b32 s48, s30, 3
    s_add_u32 s48, s48, 100160
    v_lshl_add_u32 v234, v3, 2, s48
Lp3s_done:
    s_cmp_ge_u32 s30, 5
    s_cbranch_scc1 Lnog2
    s_mov_b32 s34, 100000
    s_bfe_u32 s48, s31, 0x80000
    s_bfe_u32 s49, s31, 0x80008
    s_bfe_u32 s50, s31, 0x80010
    s_bfe_u32 s51, s31, 0x80018
Lg3c_10:
    s_waitcnt vmcnt(1)
    v_xor_b32 v88, s48, v88
    v_xor_b32 v89, s49, v89
    v_xor_b32 v90, s50, v90
    v_xor_b32 v91, s51, v91
    v_or_b32 v96, v88, v89
    v_or3_b32 v96, v96, v90, v91
    s_waitcnt vmcnt(0)
    v_xor_b32 v92, s48, v92
    v_xor_b32 v93, s49, v93
    v_xor_b32 v94, s50, v94
    v_xor_b32 v95, s51, v95
    v_or3_b32 v96, v96, v92, v93
    v_or3_b32 v96, v96, v94, v95
    v_and_b32 v96, 0xff, v96
    v_cmp_ne_u32 vcc, 0, v96
    s_cbranch_vccnz Lg3r_9
Lg3d_11:
    s_mov_b64 exec, -1
    ds_write_b64 v246, v[88:89] offset:5120
    ds_write_b64 v246, v[90:91] offset:5136
    ds_write_b64 v246, v[92:93] offset:10240
    ds_write_b64 v246, v[94:95] offset:10256
Lnog2:
    s_waitcnt lgkmcnt(0)
    v_lshlrev_b32 v242, 16, v4
    v_and_b32 v243, 0xffff0000, v4
    v_lshlrev_b32 v244, 16, v5
    v_and_b32 v245, 0xffff0000, v5
    v_lshlrev_b32 v246, 16, v6
    v_and_b32 v247, 0xffff0000, v6
    v_lshlrev_b32 v248, 16, v7
    v_and_b32 v249, 0xffff0000, v7
    v_lshlrev_b32 v250, 16, v8
    v_and_b32 v251, 0xffff0000, v8
    v_mov_b32 v240, 100232
    s_cmp_eq_u32 s30, 6
    s_cbranch_scc1 Lb6w
Lb6x:
    s_waitcnt vmcnt(0)
    s_barrier
    s_cmp_ge_u32 s30, 6
    s_cbranch_scc1 Lnoy
    global_load_dwordx4 v[112:115], v158, s[4:5] sc1
    v_mov_b64 v[116:117], v[236:237]
    v_mov_b64 v[118:119], v[238:239]
    s_mov_b64 exec, s[0:1]
    global_load_dwordx4 v[116:119], v158, s[20:21] sc1
    s_mov_b64 exec, -1
Lnoy:
    ds_read_b128 v[72:75], v233 offset:5120
    ds_read_b128 v[76:79], v233 offset:6144
    ds_read_b128 v[80:83], v233 offset:7168
    ds_read_b128 v[84:87], v233 offset:8192
    ds_read_b128 v[88:91], v233 offset:9216
    ds_read_b128 v[92:95], v233 offset:10240
    ds_read_b128 v[96:99], v233 offset:11264
    ds_read_b128 v[100:103], v233 offset:12288
    ds_read_b128 v[104:107], v233 offset:13312
    ds_read_b128 v[108:111], v233 offset:14336
    s_waitcnt lgkmcnt(0)
    s_cmp_ge_u32 s30, 6
    s_cbranch_scc1 Lp3_idle
    v_pk_mul_f32 v[148:149], v[148:149], v[92:93]
    v_pk_mul_f32 v[150:151], v[150:151], v[96:97]
    v_pk_mul_f32 v[152:153], v[152:153], v[100:101]
    v_pk_mul_f32 v[154:155], v[154:155], v[104:105]
    v_pk_mul_f32 v[156:157], v[156:157], v[108:109]
    s_setprio 2
    s_mov_b32 s34, 100000
Lz2c_13:
    s_waitcnt vmcnt(1)
    v_xor_b32 v112, v236, v112
    v_xor_b32 v113, v237, v113
    v_xor_b32 v114, v238, v114
    v_xor_b32 v115, v239, v115
    s_nop 1
    v_mfma_f32_16x16x32_bf16 v[120:123], v[112:115], v[12:15], 0
    v_mfma_f32_16x16x32_bf16 v[128:131], v[112:115], v[16:19], 0
    v_mfma_f32_16x16x32_bf16 v[124:127], v[112:115], v[20:23], 0
    v_mfma_f32_16x16x32_bf16 v[132:135], v[112:115], v[24:27], 0
    s_waitcnt vmcnt(0)
    v_xor_b32 v116, v236, v116
    v_xor_b32 v117, v237, v117
    v_xor_b32 v118, v238, v118
    v_xor_b32 v119, v239, v119
    s_nop 1
    v_mfma_f32_16x16x32_bf16 v[120:123], v[116:119], v[28:31], v[120:123]
    v_mfma_f32_16x16x32_bf16 v[128:131], v[116:119], v[32:35], v[128:131]
    v_mfma_f32_16x16x32_bf16 v[124:127], v[116:119], v[36:39], v[124:127]
    v_mfma_f32_16x16x32_bf16 v[132:135], v[116:119], v[40:43], v[132:135]
    v_or3_b32 v136, v112, v113, v114
    v_or3_b32 v136, v136, v115, v116
    v_or3_b32 v136, v136, v117, v118
    v_or_b32 v136, v136, v119
    v_and_b32 v136, s36, v136
    v_cmp_ne_u32 vcc, 0, v136
    s_cbranch_vccnz Lz2r_12
Lz2d_14:
    v_pk_mul_f32 v[112:113], v[128:129], v[64:65]
    v_pk_mul_f32 v[128:129], v[128:129], v[56:57]
    v_pk_mul_f32 v[114:115], v[130:131], v[66:67]
    v_pk_mul_f32 v[130:131], v[130:131], v[58:59]
    v_pk_fma_f32 v[128:129], v[120:121], v[64:65], v[128:129] neg_lo:[1,0,0] neg_hi:[1,0,0]
    v_pk_fma_f32 v[120:121], v[120:121], v[56:57], v[112:113]
    v_pk_fma_f32 v[130:131], v[122:123], v[66:67], v[130:131] neg_lo:[1,0,0] neg_hi:[1,0,0]
    v_pk_fma_f32 v[122:123], v[122:123], v[58:59], v[114:115]
    v_cvt_pk_bf16_f32 v136, v120, v121
    v_cvt_pk_bf16_f32 v138, v128, v129
    v_cvt_pk_bf16_f32 v137, v122, v123
    v_cvt_pk_bf16_f32 v139, v130, v131
    s_nop 1
    v_mfma_f32_16x16x32_bf16 v[12:15], v[136:139], v[46:49], 0
    v_mfma_f32_16x16x32_bf16 v[16:19], v[136:139], v[52:55], 0
    s_cmp_eq_u32 s32, 0
    s_cbranch_scc1 Lp3_re0
    v_mfma_f32_16x16x32_bf16 v[28:31], v[136:139], v[44:47], 0
    v_mfma_f32_16x16x32_bf16 v[32:35], v[136:139], v[50:53], 0
Lp3_re0:
    v_pk_mul_f32 v[112:113], v[132:133], v[68:69]
    v_pk_mul_f32 v[132:133], v[132:133], v[60:61]
    v_pk_mul_f32 v[114:115], v[134:135], v[70:71]
    v_pk_mul_f32 v[134:135], v[134:135], v[62:63]
    v_pk_fma_f32 v[132:133], v[124:125], v[68:69], v[132:133] neg_lo:[1,0,0] neg_hi:[1,0,0]
    v_pk_fma_f32 v[124:125], v[124:125], v[60:61], v[112:113]
    v_pk_fma_f32 v[134:135], v[126:127], v[70:71], v[134:135] neg_lo:[1,0,0] neg_hi:[1,0,0]
    v_pk_fma_f32 v[126:127], v[126:127], v[62:63], v[114:115]
    v_cvt_pk_bf16_f32 v140, v124, v125
    v_cvt_pk_bf16_f32 v142, v132, v133
    v_cvt_pk_bf16_f32 v141, v126, v127
    v_cvt_pk_bf16_f32 v143, v134, v135
    ds_write_b128 v159, v[12:15] offset:0
    ds_write_b128 v159, v[16:19] offset:2048
    v_mfma_f32_16x16x32_bf16 v[20:23], v[140:143], v[46:49], 0
    v_mfma_f32_16x16x32_bf16 v[24:27], v[140:143], v[52:55], 0
    s_cmp_eq_u32 s32, 0
    s_cbranch_scc1 Lp3_re1
    v_mfma_f32_16x16x32_bf16 v[36:39], v[140:143], v[44:47], 0
    v_mfma_f32_16x16x32_bf16 v[40:43], v[140:143], v[50:53], 0
    ds_write_b128 v159, v[28:31] offset:4096
    ds_write_b128 v159, v[32:35] offset:6144
    s_nop 0
    ds_write_b128 v146, v[20:23] offset:0
    ds_write_b128 v146, v[24:27] offset:2048
    s_nop 1
    ds_write_b128 v146, v[36:39] offset:4096
    ds_write_b128 v146, v[40:43] offset:6144
    s_branch Lp3_skip
Lp3_re1:
    s_nop 4
    ds_write_b128 v146, v[20:23] offset:0
    ds_write_b128 v146, v[24:27] offset:2048
Lp3_skip:
    s_setprio 2
    s_waitcnt lgkmcnt(0)
    s_barrier
    ds_read_b64 v[12:13], v147 offset:0
    ds_read_b64 v[22:23], v147 offset:20480
    ds_read_b64 v[14:15], v147 offset:4096
    ds_read_b64 v[24:25], v147 offset:24576
    ds_read_b64 v[16:17], v147 offset:8192
    ds_read_b64 v[26:27], v147 offset:28672
    ds_read_b64 v[18:19], v147 offset:12288
    ds_read_b64 v[28:29], v147 offset:32768
    ds_read_b64 v[20:21], v147 offset:16384
    ds_read_b64 v[30:31], v147 offset:36864
    ds_read_b64 v[32:33], v240
    s_waitcnt lgkmcnt(9)
    v_pk_add_f32 v[12:13], v[12:13], v[22:23]
    s_waitcnt lgkmcnt(7)
    v_pk_add_f32 v[14:15], v[14:15], v[24:25]
    v_pk_fma_f32 v[114:115], v[14:15], s[60:61], v[12:13] op_sel_hi:[1,0,1]
    v_pk_fma_f32 v[116:117], v[14:15], s[62:63], v[12:13] op_sel_hi:[1,0,1]
    s_waitcnt lgkmcnt(5)
    v_pk_add_f32 v[16:17], v[16:17], v[26:27]
    v_pk_mul_f32 v[118:119], v[16:17], s[64:65] op_sel_hi:[1,0]
    v_pk_mul_f32 v[120:121], v[16:17], s[66:67] op_sel_hi:[1,0]
    s_waitcnt lgkmcnt(3)
    v_pk_add_f32 v[18:19], v[18:19], v[28:29]
    v_pk_add_f32 v[112:113], v[14:15], v[18:19]
    v_pk_fma_f32 v[114:115], v[18:19], s[62:63], v[114:115] op_sel_hi:[1,0,1]
    v_pk_fma_f32 v[116:117], v[18:19], s[60:61], v[116:117] op_sel_hi:[1,0,1]
    s_waitcnt lgkmcnt(1)
    v_pk_add_f32 v[20:21], v[20:21], v[30:31]
    v_pk_fma_f32 v[112:113], v[112:113], 2.0, v[12:13] op_sel_hi:[1,0,1]
    v_pk_fma_f32 v[118:119], v[20:21], s[66:67], v[118:119] op_sel_hi:[1,0,1]
    v_pk_fma_f32 v[120:121], v[20:21], s[64:65], v[120:121] op_sel_hi:[1,0,1] neg_lo:[1,0,0] neg_hi:[1,0,0]
    v_pk_add_f32 v[122:123], v[114:115], v[118:119]
    v_pk_add_f32 v[124:125], v[116:117], v[120:121]
    v_pk_add_f32 v[126:127], v[116:117], v[120:121] neg_lo:[0,1] neg_hi:[0,1]
    v_pk_add_f32 v[128:129], v[114:115], v[118:119] neg_lo:[0,1] neg_hi:[0,1]
    v_pk_fma_f32 v[242:243], v[112:113], v[72:73], v[242:243]
    v_pk_fma_f32 v[244:245], v[122:123], v[76:77], v[244:245]
    v_pk_fma_f32 v[246:247], v[124:125], v[80:81], v[246:247]
    v_pk_fma_f32 v[248:249], v[126:127], v[84:85], v[248:249]
    v_pk_fma_f32 v[250:251], v[128:129], v[88:89], v[250:251]
    v_pk_add_f32 v[112:113], v[242:243], v[244:245]
    v_pk_mul_f32 v[114:115], v[242:243], v[242:243]
    v_pk_mul_f32 v[116:117], v[242:243], v[148:149]
    v_pk_fma_f32 v[114:115], v[244:245], v[244:245], v[114:115]
    v_pk_fma_f32 v[116:117], v[244:245], v[150:151], v[116:117]
    v_pk_add_f32 v[112:113], v[112:113], v[246:247]
    v_pk_fma_f32 v[114:115], v[246:247], v[246:247], v[114:115]
    v_pk_fma_f32 v[116:117], v[246:247], v[152:153], v[116:117]
    v_pk_add_f32 v[112:113], v[112:113], v[248:249]
    v_pk_fma_f32 v[114:115], v[248:249], v[248:249], v[114:115]
    v_pk_fma_f32 v[116:117], v[248:249], v[154:155], v[116:117]
    v_pk_add_f32 v[112:113], v[112:113], v[250:251]
    v_pk_fma_f32 v[114:115], v[250:251], v[250:251], v[114:115]
    v_pk_fma_f32 v[116:117], v[250:251], v[156:157], v[116:117]
    s_waitcnt lgkmcnt(0)
    v_add_f32 v112, v112, v113
    v_add_f32 v114, v114, v115
    v_permlane32_swap_b32 v116, v117
    s_nop 0
    v_permlane32_swap_b32 v112, v114
    v_add_f32 v116, v116, v117
    v_add_f32 v112, v112, v114
    s_nop 1
    v_permlane16_swap_b32 v112, v116
    v_add_f32 v112, v112, v116
    s_nop 1
    v_add_f32_dpp v112, v112, v112 row_ror:8 row_mask:0xf bank_mask:0xf
    s_nop 1
    v_add_f32_dpp v112, v112, v112 row_ror:4 row_mask:0xf bank_mask:0xf
    s_nop 1
    v_add_f32_dpp v112, v112, v112 row_ror:2 row_mask:0xf bank_mask:0xf
    s_nop 1
    v_add_f32_dpp v112, v112, v112 row_ror:1 row_mask:0xf bank_mask:0xf
    s_nop 0
    v_readlane_b32 s48, v112, 0
    v_readlane_b32 s49, v112, 32
    v_readlane_b32 s50, v112, 16
    v_readlane_b32 s51, v112, 48
    v_mul_f32 v113, s48, v252
    v_fma_f32 v114, s49, v252, v253
    v_mov_b32 v118, s50
    v_fma_f32 v114, -v113, v113, v114
    v_add_f32 v118, s51, v118
    v_max_f32 v114, v253, v114
    v_fma_f32 v118, -v113, v32, v118
    v_rsq_f32 v114, v114
    s_nop 0
    v_fma_f32 v118, v118, v114, v33
    v_med3_f32 v118, v118, v254, -v254
    v_bfi_b32 v118, v255, s37, v118
    ds_write_b32 v9, v118
    v_mul_f32_e64 v116, -v113, v114
    s_waitcnt lgkmcnt(0)
    s_barrier
    ds_read_b32 v121, v10
    v_mov_b32 v119, s31
    s_sub_u32 s39, s2, 200
    s_mov_b32 s35, 0
    s_waitcnt lgkmcnt(0)
    v_cmp_gt_f32 vcc, v121, v118
    s_cbranch_vccnz Lnotbest
    s_mov_b64 exec, 0xff
    global_store_dwordx2 v11, v[118:119], s[28:29] sc1
    s_mov_b64 exec, -1
    s_setprio 3
    s_mov_b32 s35, 1
Lnotbest:
    v_pk_fma_f32 v[56:57], v[242:243], v[114:115], v[116:117] op_sel_hi:[1,0,0]
    v_pk_fma_f32 v[58:59], v[244:245], v[114:115], v[116:117] op_sel_hi:[1,0,0]
    v_pk_fma_f32 v[60:61], v[246:247], v[114:115], v[116:117] op_sel_hi:[1,0,0]
    v_pk_fma_f32 v[62:63], v[248:249], v[114:115], v[116:117] op_sel_hi:[1,0,0]
    v_pk_fma_f32 v[64:65], v[250:251], v[114:115], v[116:117] op_sel_hi:[1,0,0]
    v_pk_fma_f32 v[56:57], v[56:57], v[92:93], v[74:75]
    v_pk_fma_f32 v[58:59], v[58:59], v[96:97], v[78:79]
    v_pk_fma_f32 v[60:61], v[60:61], v[100:101], v[82:83]
    v_pk_fma_f32 v[62:63], v[62:63], v[104:105], v[86:87]
    v_pk_fma_f32 v[64:65], v[64:65], v[108:109], v[90:91]
    v_pk_fma_f32 v[124:125], v[56:57], v[94:95], v[242:243]
    v_pk_fma_f32 v[128:129], v[58:59], v[98:99], v[244:245]
    v_pk_fma_f32 v[132:133], v[60:61], v[102:103], v[246:247]
    v_pk_fma_f32 v[136:137], v[62:63], v[106:107], v[248:249]
    v_pk_fma_f32 v[140:141], v[64:65], v[110:111], v[250:251]
    s_cmp_eq_u32 s35, 0
    s_cbranch_scc1 Lnorec
    s_mul_i32 s48, s2, 5120
    s_add_u32 s48, s48, 10487808
    v_add_u32 v120, s48, v233
    v_cvt_pk_bf16_f32 v126, v56, v57
    v_mov_b32 v127, s31
    global_store_dwordx4 v120, v[124:127], s[28:29] offset:-2048 sc1
    v_cvt_pk_bf16_f32 v130, v58, v59
    v_mov_b32 v131, s31
    global_store_dwordx4 v120, v[128:131], s[28:29] offset:-1024 sc1
    v_cvt_pk_bf16_f32 v134, v60, v61
    v_mov_b32 v135, s31
    global_store_dwordx4 v120, v[132:135], s[28:29] offset:0 sc1
    v_cvt_pk_bf16_f32 v138, v62, v63
    v_mov_b32 v139, s31
    global_store_dwordx4 v120, v[136:139], s[28:29] offset:1024 sc1
    v_cvt_pk_bf16_f32 v142, v64, v65
    v_mov_b32 v143, s31
    global_store_dwordx4 v120, v[140:143], s[28:29] offset:2048 sc1
Lnorec:
    v_cvt_pk_bf16_f32 v4, v124, v125
    v_cvt_pk_bf16_f32 v5, v128, v129
    v_cvt_pk_bf16_f32 v6, v132, v133
    v_cvt_pk_bf16_f32 v7, v136, v137
    v_cvt_pk_bf16_f32 v8, v140, v141
    s_cmp_lt_u32 s39, 48
    s_cbranch_scc1 Largmax
    s_cmp_eq_u32 s35, 0
    s_cbranch_scc1 Lstore
    v_mov_b32 v120, 1024
    s_mov_b64 exec, 1
    s_mov_b32 s34, 100000
Lpoll_15:
    global_load_dwordx2 v[122:123], v120, s[28:29] sc1
    s_waitcnt vmcnt(0)
    v_cmp_ne_u32 vcc, s31, v123
    s_cbranch_vccz Lok_16
    s_mov_b64 exec, vcc
    s_sub_u32 s34, s34, 1
    s_cbranch_scc0 Lpoll_15
Lok_16:
    s_mov_b64 exec, -1
    v_readfirstlane_b32 s48, v122
    s_and_b32 s48, s48, 2047
    s_cmp_eq_u32 s48, s37
    s_cbranch_scc1 k0_end
    global_store_dword v1, v4, s[24:25] offset:0 sc1
    global_store_dword v1, v5, s[24:25] offset:256 sc1
    global_store_dword v1, v6, s[24:25] offset:512 sc1
    global_store_dword v1, v7, s[24:25] offset:768 sc1
    global_store_dword v1, v8, s[24:25] offset:1024 sc1
    s_branch k0_end
Lstore:
    global_store_dword v1, v4, s[24:25] offset:0 sc1
    s_waitcnt vmcnt(0)
    global_store_dword v1, v5, s[24:25] offset:256 sc1
    s_waitcnt vmcnt(0)
    global_store_dword v1, v6, s[24:25] offset:512 sc1
    s_waitcnt vmcnt(0)
    global_store_dword v1, v7, s[24:25] offset:768 sc1
    s_waitcnt vmcnt(0)
    global_store_dword v1, v8, s[24:25] offset:1024 sc1
    s_branch k0_end
Largmax:
    s_cmp_lg_u32 s35, 0
    s_cbranch_scc1 Lmo
    global_store_dword v1, v4, s[24:25] offset:0 sc1
    global_store_dword v1, v5, s[24:25] offset:256 sc1
    global_store_dword v1, v6, s[24:25] offset:512 sc1
    global_store_dword v1, v7, s[24:25] offset:768 sc1
    global_store_dword v1, v8, s[24:25] offset:1024 sc1
Lmo:
    s_and_b32 s48, s2, 7
    s_mul_i32 s48, s48, 2304
    s_lshl_b32 s49, s30, 8
    s_add_u32 s48, s48, s49
    s_add_u32 s48, s48, 16384
    v_lshl_add_u32 v16, v0, 3, s48
    v_mov_b32 v14, 0
    v_mov_b32 v15, 0
    s_mov_b32 exec_hi, 0
    global_atomic_add_x2 v[12:13], v16, v[14:15], s[28:29] sc0 sc1
    s_mov_b64 exec, -1
    s_mul_i32 s49, s32, 1280
    s_add_u32 s49, s49, 10485768
    v_lshrrev_b32 v112, 2, v0
    v_lshl_add_u32 v112, v112, 4, s49
    v_and_b32 v116, 3, v0
    v_lshlrev_b32 v116, 5, v116
    v_lshl_add_u32 v116, v3, 3, v116
    s_lshl_b32 s48, s30, 7
    s_add_u32 s48, s48, 100240
    v_add_u32 v116, s48, v116
    v_and_b32 v125, 7, v0
    v_lshl_add_u32 v113, v3, 3, v125
    v_lshlrev_b32 v113, 2, v113
    v_add_u32 v113, 100240, v113
    v_lshrrev_b32 v117, 3, v0
    v_mul_u32_u24 v117, 6144, v117
    v_lshl_add_u32 v117, v125, 4, v117
    s_mul_i32 s48, s30, 49152
    s_lshl_b32 s49, s38, 7
    s_add_u32 s48, s48, s49
    s_add_u32 s48, s48, 65536
    v_add_u32 v117, s48, v117
    v_mov_b32 v121, s31
    v_mov_b32 v123, s31
    s_mul_i32 s48, s38, 6144
    s_add_u32 s48, s48, 67584
    v_add_u32 v124, s48, v233
    s_min_u32 s50, s38, 39
    s_lshl_b32 s48, s50, 3
    v_add_u32 v125, s48, v125
    v_and_b32 v118, 3, v0
    v_and_b32 v119, 60, v0
    v_lshl_add_u32 v118, v118, 6, v119
    v_lshrrev_b32 v126, 5, v0
    v_lshlrev_b32 v127, 4, v125
    v_lshl_add_u32 v128, v126, 2, v127
    ds_read_b32 v129, v128 offset:10248
    v_add_u32 v127, 10485760, v127
    v_lshl_add_u32 v125, v125, 1, v126
    v_lshlrev_b32 v125, 1, v125
    v_mov_b32 v18, 100160
    s_mov_b32 s55, -1
    s_waitcnt vmcnt(48)
    v_perm_b32 v72, v164, v160, s58
    v_perm_b32 v73, v164, v160, s59
    v_perm_b32 v74, v165, v161, s58
    v_perm_b32 v75, v165, v161, s59
    v_perm_b32 v76, v166, v162, s58
    v_perm_b32 v77, v166, v162, s59
    v_perm_b32 v78, v167, v163, s58
    v_perm_b32 v79, v167, v163, s59
    s_waitcnt vmcnt(46)
    v_perm_b32 v80, v172, v168, s58
    v_perm_b32 v81, v172, v168, s59
    v_perm_b32 v82, v173, v169, s58
    v_perm_b32 v83, v173, v169, s59
    v_perm_b32 v84, v174, v170, s58
    v_perm_b32 v85, v174, v170, s59
    v_perm_b32 v86, v175, v171, s58
    v_perm_b32 v87, v175, v171, s59
    s_waitcnt vmcnt(44)
    v_perm_b32 v88, v180, v176, s58
    v_perm_b32 v89, v180, v176, s59
    v_perm_b32 v90, v181, v177, s58
    v_perm_b32 v91, v181, v177, s59
    v_perm_b32 v92, v182, v178, s58
    v_perm_b32 v93, v182, v178, s59
    v_perm_b32 v94, v183, v179, s58
    v_perm_b32 v95, v183, v179, s59
    s_waitcnt vmcnt(42)
    v_perm_b32 v96, v188, v184, s58
    v_perm_b32 v97, v188, v184, s59
    v_perm_b32 v98, v189, v185, s58
    v_perm_b32 v99, v189, v185, s59
    v_perm_b32 v100, v190, v186, s58
    v_perm_b32 v101, v190, v186, s59
    v_perm_b32 v102, v191, v187, s58
    v_perm_b32 v103, v191, v187, s59
    s_waitcnt vmcnt(40)
    v_perm_b32 v104, v196, v192, s58
    v_perm_b32 v105, v196, v192, s59
    v_perm_b32 v106, v197, v193, s58
    v_perm_b32 v107, v197, v193, s59
    v_perm_b32 v108, v198, v194, s58
    v_perm_b32 v109, v198, v194, s59
    v_perm_b32 v110, v199, v195, s58
    v_perm_b32 v111, v199, v195, s59
    s_waitcnt vmcnt(40)
    s_cmp_ge_u32 s30, 5
    s_cbranch_scc1 Lnodp_18
    v_perm_b32 v160, v204, v200, s58
    v_perm_b32 v161, v212, v208, s58
    v_perm_b32 v162, v220, v216, s58
    v_perm_b32 v163, v228, v224, s58
    v_perm_b32 v164, v204, v200, s59
    v_perm_b32 v165, v212, v208, s59
    v_perm_b32 v166, v220, v216, s59
    v_perm_b32 v167, v228, v224, s59
    v_perm_b32 v168, v205, v201, s58
    v_perm_b32 v169, v213, v209, s58
    v_perm_b32 v170, v221, v217, s58
    v_perm_b32 v171, v229, v225, s58
    v_perm_b32 v172, v205, v201, s59
    v_perm_b32 v173, v213, v209, s59
    v_perm_b32 v174, v221, v217, s59
    v_perm_b32 v175, v229, v225, s59
    v_perm_b32 v176, v206, v202, s58
    v_perm_b32 v177, v214, v210, s58
    v_perm_b32 v178, v222, v218, s58
    v_perm_b32 v179, v230, v226, s58
    v_perm_b32 v180, v206, v202, s59
    v_perm_b32 v181, v214, v210, s59
    v_perm_b32 v182, v222, v218, s59
    v_perm_b32 v183, v230, v226, s59
    v_perm_b32 v184, v207, v203, s58
    v_perm_b32 v185, v215, v211, s58
    v_perm_b32 v186, v223, v219, s58
    v_perm_b32 v187, v231, v227, s58
    v_perm_b32 v188, v207, v203, s59
    v_perm_b32 v189, v215, v211, s59
    v_perm_b32 v190, v223, v219, s59
    v_perm_b32 v191, v231, v227, s59
Lnodp_18:
    s_mov_b32 exec_hi, 0
    s_mov_b32 s34, 100000
    s_branch Lchk_21
Lpoll_19:
    global_atomic_add_x2 v[12:13], v16, v[14:15], s[28:29] sc0 sc1
Lchk_21:
    s_waitcnt vmcnt(0)
    v_cmp_ne_u32 vcc, s31, v13
    s_cbranch_vccz Lok_20
    s_mov_b64 exec, vcc
    s_sub_u32 s34, s34, 1
    s_cbranch_scc0 Lpoll_19
Lok_20:
    s_mov_b64 exec, -1
    v_max_f32_dpp v12, v12, v12 row_ror:8 row_mask:0xf bank_mask:0xf
    s_nop 1
    v_max_f32_dpp v12, v12, v12 row_ror:4 row_mask:0xf bank_mask:0xf
    s_nop 1
    v_max_f32_dpp v12, v12, v12 row_ror:2 row_mask:0xf bank_mask:0xf
    s_nop 1
    v_max_f32_dpp v12, v12, v12 row_ror:1 row_mask:0xf bank_mask:0xf
    s_mov_b64 exec, 0x10001
    ds_write_b32 v234, v12
    s_mov_b64 exec, -1
    s_waitcnt lgkmcnt(0)
    s_barrier
    ds_read_b128 v[20:23], v18 offset:0
    ds_read_b128 v[24:27], v18 offset:16
    ds_read_b128 v[28:31], v18 offset:32
    ds_read_b128 v[32:35], v18 offset:48
    s_waitcnt lgkmcnt(2)
    v_max3_f32 v12, v20, v21, v22
    v_max3_f32 v13, v23, v24, v25
    v_max3_f32 v12, v12, v26, v27
    s_waitcnt lgkmcnt(0)
    v_max3_f32 v13, v13, v28, v29
    v_max3_f32 v12, v12, v30, v31
    v_max3_f32 v13, v13, v32, v33
    v_max3_f32 v12, v12, v34, v35
    v_max_f32 v130, v12, v13
    v_and_b32 v12, 255, v130
    v_mul_u32_u24 v12, 5120, v12
    v_add_u32 v112, v12, v112
    global_load_dwordx2 v[14:15], v112, s[28:29] offset:0 sc1
    global_load_dwordx2 v[16:17], v112, s[28:29] offset:256 sc1
    global_load_dwordx2 v[18:19], v112, s[28:29] offset:512 sc1
    global_load_dwordx2 v[20:21], v112, s[28:29] offset:768 sc1
    global_load_dwordx2 v[22:23], v112, s[28:29] offset:1024 sc1
    v_readfirstlane_b32 s57, v130
    v_add_u32 v127, v12, v127
    s_and_b32 s56, s57, 2047
    s_mul_i32 s48, s56, 1280
    v_add_u32 v125, s48, v125
    s_mov_b32 s34, 100000
Lh2c:
    s_waitcnt vmcnt(4)
    v_xor_b32 v114, v241, v15
    v_dot2_f32_bf16 v24, v72, v14, 0
    v_dot2_f32_bf16 v25, v73, v14, 0
    v_dot2_f32_bf16 v26, v74, v14, 0
    v_dot2_f32_bf16 v27, v75, v14, 0
    v_dot2_f32_bf16 v28, v76, v14, 0
    v_dot2_f32_bf16 v29, v77, v14, 0
    v_dot2_f32_bf16 v30, v78, v14, 0
    v_dot2_f32_bf16 v31, v79, v14, 0
    s_waitcnt vmcnt(3)
    v_bitop3_b32 v114, v114, v241, v17 bitop3:0xf6
    v_dot2_f32_bf16 v24, v80, v16, v24
    v_dot2_f32_bf16 v25, v81, v16, v25
    v_dot2_f32_bf16 v26, v82, v16, v26
    v_dot2_f32_bf16 v27, v83, v16, v27
    v_dot2_f32_bf16 v28, v84, v16, v28
    v_dot2_f32_bf16 v29, v85, v16, v29
    v_dot2_f32_bf16 v30, v86, v16, v30
    v_dot2_f32_bf16 v31, v87, v16, v31
    s_waitcnt vmcnt(2)
    v_bitop3_b32 v114, v114, v241, v19 bitop3:0xf6
    v_dot2_f32_bf16 v24, v88, v18, v24
    v_dot2_f32_bf16 v25, v89, v18, v25
    v_dot2_f32_bf16 v26, v90, v18, v26
    v_dot2_f32_bf16 v27, v91, v18, v27
    v_dot2_f32_bf16 v28, v92, v18, v28
    v_dot2_f32_bf16 v29, v93, v18, v29
    v_dot2_f32_bf16 v30, v94, v18, v30
    v_dot2_f32_bf16 v31, v95, v18, v31
    s_waitcnt vmcnt(1)
    v_bitop3_b32 v114, v114, v241, v21 bitop3:0xf6
    v_dot2_f32_bf16 v24, v96, v20, v24
    v_dot2_f32_bf16 v25, v97, v20, v25
    v_dot2_f32_bf16 v26, v98, v20, v26
    v_dot2_f32_bf16 v27, v99, v20, v27
    v_dot2_f32_bf16 v28, v100, v20, v28
    v_dot2_f32_bf16 v29, v101, v20, v29
    v_dot2_f32_bf16 v30, v102, v20, v30
    v_dot2_f32_bf16 v31, v103, v20, v31
    s_waitcnt vmcnt(0)
    v_bitop3_b32 v114, v114, v241, v23 bitop3:0xf6
    v_cmp_ne_u32 vcc, 0, v114
    v_dot2_f32_bf16 v24, v104, v22, v24
    v_dot2_f32_bf16 v25, v105, v22, v25
    v_dot2_f32_bf16 v26, v106, v22, v26
    v_dot2_f32_bf16 v27, v107, v22, v27
    v_dot2_f32_bf16 v28, v108, v22, v28
    v_dot2_f32_bf16 v29, v109, v22, v29
    v_dot2_f32_bf16 v30, v110, v22, v30
    v_dot2_f32_bf16 v31, v111, v22, v31
    s_cbranch_vccnz Lh2r
Lh2d:
    v_permlane32_swap_b32 v24, v28
    v_permlane32_swap_b32 v25, v29
    v_permlane32_swap_b32 v26, v30
    v_permlane32_swap_b32 v27, v31
    v_add_f32 v24, v24, v28
    v_add_f32 v25, v25, v29
    v_add_f32 v26, v26, v30
    v_add_f32 v27, v27, v31
    s_nop 0
    v_permlane16_swap_b32 v24, v26
    v_permlane16_swap_b32 v25, v27
    v_add_f32 v24, v24, v26
    v_add_f32 v25, v25, v27
    s_nop 0
    v_add_f32_dpp v24, v24, v24 row_ror:8 row_mask:0xf bank_mask:0xf
    v_add_f32_dpp v25, v25, v25 row_ror:8 row_mask:0xf bank_mask:0xf
    s_nop 0
    v_add_f32_dpp v24, v24, v24 row_ror:4 row_mask:0xf bank_mask:0xf
    v_add_f32_dpp v25, v25, v25 row_ror:4 row_mask:0xf bank_mask:0xf
    ds_write_b64 v116, v[24:25]
    s_cmp_lg_u32 s37, 1992
    s_cbranch_scc1 Lnotw7
    v_mov_b32 v132, 0
    v_mov_b32 v131, s31
    s_mov_b64 exec, 1
    global_store_dwordx2 v132, v[130:131], s[28:29] offset:1024 sc1
    global_store_dword v132, v131, s[28:29] sc1
    s_mov_b64 exec, -1
Lnotw7:
    s_cmp_eq_u32 s56, s37
    s_cbranch_scc1 Lwon
    s_cmp_eq_u32 s35, 0
    s_cbranch_scc1 Lwon
    global_store_dword v1, v4, s[24:25] offset:0 sc1
    global_store_dword v1, v5, s[24:25] offset:256 sc1
    global_store_dword v1, v6, s[24:25] offset:512 sc1
    global_store_dword v1, v7, s[24:25] offset:768 sc1
    global_store_dword v1, v8, s[24:25] offset:1024 sc1
Lwon:
    s_waitcnt lgkmcnt(0)
    s_barrier
    s_cmp_ge_u32 s30, 5
    s_cbranch_scc1 k0_end
    ds_read2_b32 v[12:13], v113 offset0:0 offset1:32
    ds_read2_b32 v[14:15], v113 offset0:64 offset1:96
    ds_read2_b32 v[16:17], v113 offset0:128 offset1:160
    ds_read2_b32 v[18:19], v113 offset0:192 offset1:224
    s_waitcnt lgkmcnt(2)
    v_pk_add_f32 v[12:13], v[12:13], v[14:15]
    s_waitcnt lgkmcnt(0)
    v_pk_add_f32 v[16:17], v[16:17], v[18:19]
    v_pk_add_f32 v[12:13], v[12:13], v[16:17]
    v_mul_f32 v14, 0xbfb8aa3b, v12
    v_exp_f32 v14, v14
    v_mul_f32 v12, v12, v13
    v_add_f32 v14, 1.0, v14
    v_rcp_f32 v14, v14
    s_nop 0
    v_mul_f32 v12, v12, v14
    s_nop 1
    v_mov_b32_dpp v13, v12 quad_perm:[1,1,3,3] row_mask:0xf bank_mask:0xf
    v_cvt_pk_bf16_f32 v12, v12, v13
    s_nop 1
    v_mov_b32_dpp v16, v12 row_newbcast:0 row_mask:0xf bank_mask:0xf
    v_mov_b32_dpp v17, v12 row_newbcast:2 row_mask:0xf bank_mask:0xf
    v_mov_b32_dpp v18, v12 row_newbcast:4 row_mask:0xf bank_mask:0xf
    v_mov_b32_dpp v19, v12 row_newbcast:6 row_mask:0xf bank_mask:0xf
    s_nop 1
    v_mfma_f32_16x16x32_bf16 v[24:27], v[16:19], v[160:163], 0
    v_mfma_f32_16x16x32_bf16 v[28:31], v[16:19], v[164:167], 0
    v_mfma_f32_16x16x32_bf16 v[32:35], v[16:19], v[168:171], 0
    v_mfma_f32_16x16x32_bf16 v[36:39], v[16:19], v[172:175], 0
    v_mfma_f32_16x16x32_bf16 v[40:43], v[16:19], v[176:179], 0
    v_mfma_f32_16x16x32_bf16 v[44:47], v[16:19], v[180:183], 0
    v_mfma_f32_16x16x32_bf16 v[48:51], v[16:19], v[184:187], 0
    v_mfma_f32_16x16x32_bf16 v[52:55], v[16:19], v[188:191], 0
    s_nop 0
    v_mov_b32 v120, v24
    v_mov_b32 v122, v28
    s_nop 0
    v_mov_b32_dpp v120, v32 quad_perm:[0,1,2,3] row_mask:0x2 bank_mask:0xf
    v_mov_b32_dpp v122, v36 quad_perm:[0,1,2,3] row_mask:0x2 bank_mask:0xf
    s_nop 0
    v_mov_b32_dpp v120, v40 quad_perm:[0,1,2,3] row_mask:0x4 bank_mask:0xf
    v_mov_b32_dpp v122, v44 quad_perm:[0,1,2,3] row_mask:0x4 bank_mask:0xf
    s_nop 0
    v_mov_b32_dpp v120, v48 quad_perm:[0,1,2,3] row_mask:0x8 bank_mask:0xf
    v_mov_b32_dpp v122, v52 quad_perm:[0,1,2,3] row_mask:0x8 bank_mask:0xf
    ds_bpermute_b32 v120, v118, v120
    ds_bpermute_b32 v122, v118, v122
    s_waitcnt lgkmcnt(0)
    global_store_dwordx4 v117, v[120:123], s[28:29] sc1
    s_cmp_lg_u32 s30, 4
    s_cbranch_scc1 k0_end
    s_cmp_ge_u32 s38, 40
    s_cbranch_scc1 k0_end
    global_load_dwordx4 v[216:219], v127, s[28:29] sc1
    v_mul_f32 v131, 0xbfb8aa3b, v130
    v_exp_f32 v131, v131
    s_nop 0
    v_add_f32 v131, 1.0, v131
    v_rcp_f32 v131, v131
    s_nop 0
    v_mul_f32 v131, v131, v129
    s_mov_b32 s34, 100000
    s_branch Lchk_24
Lpoll_22:
    global_load_dwordx4 v[216:219], v127, s[28:29] sc1
Lchk_24:
    s_waitcnt vmcnt(0)
    v_cmp_ne_u32 vcc, s31, v219
    s_cbranch_vccz Lok_23
    s_mov_b64 exec, vcc
    s_sub_u32 s34, s34, 1
    s_cbranch_scc0 Lpoll_22
Lok_23:
    s_mov_b64 exec, -1
    v_mov_b32_dpp v216, v217 quad_perm:[0,1,2,3] row_mask:0xc bank_mask:0xf
    s_waitcnt vmcnt(0)
    s_mov_b32 s34, 100000
Lpr:
    global_load_dwordx4 v[192:195], v124, s[28:29] offset:-2048 sc1
    global_load_dwordx4 v[196:199], v124, s[28:29] offset:-1024 sc1
    global_load_dwordx4 v[200:203], v124, s[28:29] offset:0 sc1
    global_load_dwordx4 v[204:207], v124, s[28:29] offset:1024 sc1
    global_load_dwordx4 v[208:211], v124, s[28:29] offset:2048 sc1
    global_load_dwordx4 v[212:215], v124, s[28:29] offset:3072 sc1
    s_waitcnt vmcnt(5)
    v_xor_b32 v132, v241, v193
    v_bitop3_b32 v132, v132, v241, v195 bitop3:0xf6
    s_waitcnt vmcnt(4)
    v_bitop3_b32 v132, v132, v241, v197 bitop3:0xf6
    v_bitop3_b32 v132, v132, v241, v199 bitop3:0xf6
    v_add_f32 v192, v192, v196
    v_add_f32 v194, v194, v198
    s_waitcnt vmcnt(3)
    v_bitop3_b32 v132, v132, v241, v201 bitop3:0xf6
    v_bitop3_b32 v132, v132, v241, v203 bitop3:0xf6
    v_add_f32 v192, v192, v200
    v_add_f32 v194, v194, v202
    s_waitcnt vmcnt(2)
    v_bitop3_b32 v132, v132, v241, v205 bitop3:0xf6
    v_bitop3_b32 v132, v132, v241, v207 bitop3:0xf6
    v_add_f32 v192, v192, v204
    v_add_f32 v194, v194, v206
    s_waitcnt vmcnt(1)
    v_bitop3_b32 v132, v132, v241, v209 bitop3:0xf6
    v_bitop3_b32 v132, v132, v241, v211 bitop3:0xf6
    v_add_f32 v192, v192, v208
    v_add_f32 v194, v194, v210
    s_waitcnt vmcnt(0)
    v_bitop3_b32 v132, v132, v241, v213 bitop3:0xf6
    v_bitop3_b32 v132, v132, v241, v215 bitop3:0xf6
    v_cmp_ne_u32 vcc, 0, v132
    v_add_f32 v192, v192, v212
    v_add_f32 v194, v194, v214
    s_cbranch_vccz Lpd
    s_sub_u32 s34, s34, 1
    s_cbranch_scc0 Lpr
Lpd:
    s_nop 0
    v_permlane32_swap_b32 v192, v194
    v_add_f32 v192, v192, v194
    v_mov_b32 v194, v192
    s_nop 1
    v_permlane16_swap_b32 v192, v194
    v_add_f32 v192, v192, v194
    s_nop 1
    v_add_f32_dpp v192, v192, v192 row_ror:8 row_mask:0xf bank_mask:0xf
    v_fmac_f32 v216, v192, v131
    s_nop 1
    v_permlane32_swap_b32 v216, v217
    v_cvt_pk_bf16_f32 v216, v216, v217
    s_mov_b64 exec, 0xff
    global_store_dword v125, v216, s[26:27] sc1
    s_branch k0_end
Lw7b:
    v_mov_b32 v64, 0
    v_mov_b32 v68, 0
    v_lshlrev_b32 v232, 4, v0
    v_and_b32 v0, 63, v0
    v_lshlrev_b32 v1, 2, v0
    v_lshlrev_b32 v233, 4, v0
    v_and_b32 v2, 15, v0
    v_lshrrev_b32 v3, 4, v0
    s_lshl_b32 s37, s30, 8
    s_add_u32 s37, s37, s2
    s_mul_i32 s55, s37, 1280
    s_lshr_b32 s32, s30, 1
    s_and_b32 s33, s30, 1
    s_mov_b32 s58, 0x05040100
    s_mov_b32 s59, 0x07060302
    s_mov_b32 s36, 0x40004000
    s_and_b32 s48, s2, 7
    s_mul_i32 s39, s48, 105728
    s_add_u32 s39, s39, 524288
    s_lshr_b32 s49, s2, 6
    s_add_u32 s49, s49, 1
    s_cmp_lt_u32 s2, 128
    s_cselect_b32 s49, s49, 0
    s_bfe_u32 s50, s2, 0x30003
    s_sub_u32 s51, 0, s48
    s_and_b32 s51, s51, 7
    s_cmp_lt_u32 s50, 4
    s_cselect_b32 s51, s48, s51
    s_lshl_b32 s35, s49, 3
    s_add_u32 s35, s35, s51
    s_lshl_b32 s35, s35, 3
    s_add_u32 s35, s35, s50
    s_and_b32 s48, s2, 7
    s_mul_i32 s48, s48, 245760
    s_lshr_b32 s49, s2, 3
    s_sub_u32 s49, s49, 25
    s_mul_i32 s49, s49, 35200
    s_min_u32 s49, s49, 210560
    s_add_u32 s48, s48, s49
    v_lshl_add_u32 v44, v0, 7, s48
    v_add_u32 v45, 7040, v44
    v_add_u32 v46, 14080, v44
    v_add_u32 v47, 21120, v44
    v_add_u32 v48, 28160, v44
    s_waitcnt lgkmcnt(0)
    s_mov_b32 exec_hi, 0x7fffff
    global_load_dword v12, v44, s[18:19]
    s_mov_b64 exec, -1
    s_load_dword s31, s[28:29], 0
    s_add_u32 s4, s4, s55
    s_addc_u32 s5, s5, 0
    s_mov_b64 s[26:27], s[24:25]
    s_add_u32 s24, s24, s55
    s_addc_u32 s25, s25, 0
    s_mul_i32 s48, s57, 15360
    s_lshl_b32 s49, s56, 7
    s_add_u32 s48, s48, s49
    s_sub_u32 s50, s2, 200
    s_lshl_b32 s50, s50, 7
    s_add_u32 s50, s50, 76800
    s_cmp_ge_u32 s2, 200
    s_cselect_b32 s48, s50, s48
    s_add_u32 s48, s48, 524288
    v_lshrrev_b32 v49, 3, v0
    v_mul_u32_u24 v49, 105728, v49
    v_and_b32 v50, 7, v0
    v_lshl_add_u32 v49, v50, 4, v49
    v_add_u32 v49, s48, v49
    v_and_b32 v51, 1, v0
    v_and_b32 v50, 6, v0
    v_lshlrev_b32 v50, 1, v50
    v_lshl_add_u32 v50, v51, 7, v50
    v_add_u32 v51, 64, v50
    s_waitcnt lgkmcnt(0)
    s_lshl_b32 s48, s31, 16
    s_xor_b32 s31, s31, s48
    s_xor_b32 s31, s31, 0xffff
    v_mov_b32 v241, s31
    v_and_b32 v114, 3, v0
    v_lshl_add_u32 v115, v114, 2, 18
    v_alignbit_b32 v236, s31, s31, v115
    v_and_b32 v236, s36, v236
    v_add_u32 v115, 1, v115
    v_alignbit_b32 v237, s31, s31, v115
    v_and_b32 v237, s36, v237
    v_add_u32 v115, 1, v115
    v_alignbit_b32 v238, s31, s31, v115
    v_and_b32 v238, s36, v238
    v_add_u32 v115, 1, v115
    v_alignbit_b32 v239, s31, s31, v115
    v_and_b32 v239, s36, v239
    v_add_u32 v115, 18, v2
    v_alignbit_b32 v240, s31, s31, v115
    v_and_b32 v240, s36, v240
    s_waitcnt vmcnt(0)
    global_store_dwordx4 v49, v[44:47], s[28:29] sc1
    global_load_dword v4, v1, s[4:5] offset:0
    global_load_dword v5, v1, s[4:5] offset:256
    global_load_dword v6, v1, s[4:5] offset:512
    global_load_dword v7, v1, s[4:5] offset:768
    global_load_dword v8, v1, s[4:5] offset:1024
    v_mov_b32 v112, 100224
    s_waitcnt vmcnt(5)
    ds_write_b32 v112, v241 offset:4
    ds_write_b32 v112, v241
    s_setprio 0
    s_waitcnt vmcnt(0)
    v_lshlrev_b32 v132, 16, v4
    v_and_b32 v133, 0xffff0000, v4
    v_lshlrev_b32 v134, 16, v5
    v_and_b32 v135, 0xffff0000, v5
    v_lshlrev_b32 v136, 16, v6
    v_and_b32 v137, 0xffff0000, v6
    v_lshlrev_b32 v138, 16, v7
    v_and_b32 v139, 0xffff0000, v7
    v_lshlrev_b32 v140, 16, v8
    v_and_b32 v141, 0xffff0000, v8
    v_pk_add_f32 v[112:113], v[132:133], v[134:135]
    v_pk_mul_f32 v[114:115], v[132:133], v[132:133]
    v_pk_fma_f32 v[114:115], v[134:135], v[134:135], v[114:115]
    v_pk_add_f32 v[112:113], v[112:113], v[136:137]
    v_pk_fma_f32 v[114:115], v[136:137], v[136:137], v[114:115]
    v_pk_add_f32 v[112:113], v[112:113], v[138:139]
    v_pk_fma_f32 v[114:115], v[138:139], v[138:139], v[114:115]
    v_pk_add_f32 v[112:113], v[112:113], v[140:141]
    v_pk_fma_f32 v[114:115], v[140:141], v[140:141], v[114:115]
    v_add_f32 v112, v112, v113
    v_add_f32 v114, v114, v115
    s_nop 0
    v_add_f32_dpp v112, v112, v112 row_ror:8 row_mask:0xf bank_mask:0xf
    v_add_f32_dpp v114, v114, v114 row_ror:8 row_mask:0xf bank_mask:0xf
    s_nop 0
    v_add_f32_dpp v112, v112, v112 row_ror:4 row_mask:0xf bank_mask:0xf
    v_add_f32_dpp v114, v114, v114 row_ror:4 row_mask:0xf bank_mask:0xf
    s_nop 0
    v_add_f32_dpp v112, v112, v112 row_ror:2 row_mask:0xf bank_mask:0xf
    v_add_f32_dpp v114, v114, v114 row_ror:2 row_mask:0xf bank_mask:0xf
    s_nop 0
    v_add_f32_dpp v112, v112, v112 row_ror:1 row_mask:0xf bank_mask:0xf
    v_add_f32_dpp v114, v114, v114 row_ror:1 row_mask:0xf bank_mask:0xf
    s_nop 0
    v_add_f32_dpp v112, v112, v112 row_bcast:15 row_mask:0xa bank_mask:0xf
    v_add_f32_dpp v114, v114, v114 row_bcast:15 row_mask:0xa bank_mask:0xf
    s_nop 0
    v_add_f32_dpp v112, v112, v112 row_bcast:31 row_mask:0xc bank_mask:0xf
    v_add_f32_dpp v114, v114, v114 row_bcast:31 row_mask:0xc bank_mask:0xf
    v_readlane_b32 s48, v112, 63
    v_readlane_b32 s49, v114, 63
    v_mov_b32 v112, 0x3acccccd
    v_mul_f32 v113, s48, v112
    v_mul_f32 v114, s49, v112
    v_fma_f32 v114, -v113, v113, v114
    v_max_f32 v114, 0, v114
    v_add_f32 v114, 0x3727c5ac, v114
    v_rsq_f32 v114, v114
    s_nop 0
    v_mul_f32 v114, 0x2b800000, v114
    v_mul_f32_e64 v116, -v113, v114
    v_pk_fma_f32 v[132:133], v[132:133], v[114:115], v[116:117] op_sel_hi:[1,0,0]
    v_pk_fma_f32 v[134:135], v[134:135], v[114:115], v[116:117] op_sel_hi:[1,0,0]
    v_pk_fma_f32 v[136:137], v[136:137], v[114:115], v[116:117] op_sel_hi:[1,0,0]
    v_pk_fma_f32 v[138:139], v[138:139], v[114:115], v[116:117] op_sel_hi:[1,0,0]
    v_pk_fma_f32 v[140:141], v[140:141], v[114:115], v[116:117] op_sel_hi:[1,0,0]
    s_mul_i32 s48, s30, 272
    s_add_u32 s48, s48, 15360
    v_add_u32 v142, s48, v1
    s_mov_b32 s60, 0x3e9e377a
    s_mov_b32 s62, 0xbf4f1bbd
    s_mov_b32 s64, 0xbf737871
    s_mov_b32 s66, 0xbf167918
    v_mul_u32_u24 v144, 544, v3
    v_lshrrev_b32 v145, 2, v2
    v_lshl_add_u32 v144, v145, 6, v144
    v_and_b32 v145, 3, v2
    v_lshl_add_u32 v144, v145, 3, v144
    s_lshl_b32 s48, s32, 1
    s_max_u32 s48, s48, 1
    s_sub_u32 s48, s48, 1
    s_mul_i32 s48, s48, 2176
    s_add_u32 s48, s48, 15360
    v_add_u32 v144, s48, v144
    s_lshl_b32 s48, s30, 11
    s_mul_i32 s49, s2, 12544
    s_add_u32 s49, s48, s49
    s_add_u32 s49, s49, 2097152
    v_lshlrev_b32 v145, 9, v3
    v_lshl_add_u32 v145, v2, 4, v145
    s_add_u32 s42, s28, s49
    s_addc_u32 s43, s29, 0
    s_mul_i32 s49, s35, 16640
    s_add_u32 s48, s48, s49
    s_add_u32 s48, s48, 6291456
    s_add_u32 s44, s28, s48
    s_addc_u32 s45, s29, 0
    s_lshr_b32 s49, s35, 6
    s_and_b32 s50, s35, 7
    s_bfe_u32 s51, s35, 0x30003
    s_cmp_lt_u32 s50, 4
    s_cselect_b32 s52, 1, -1
    s_cselect_b32 s53, 0, 640
    s_lshl_b32 s50, s50, 4
    v_add_u32 v112, s50, v2
    v_mad_u32_u24 v112, v112, 5, s49
    v_mul_i32_i24 v112, s52, v112
    v_add_lshl_u32 v112, v112, s53, 1
    s_lshl_b32 s50, s30, 4
    s_add_u32 s50, s50, s51
    v_lshl_add_u32 v113, v3, 9, s50
    v_mul_i32_i24 v113, s52, v113
    s_movk_i32 s53, 642
    v_and_b32 v224, 2047, v113
    v_mad_u32_u24 v224, v224, s53, v112
    s_mul_i32 s48, s52, 128
    v_add_u32 v225, s48, v113
    v_and_b32 v225, 2047, v225
    v_mad_u32_u24 v225, v225, s53, v112
    s_mul_i32 s48, s52, 256
    v_add_u32 v226, s48, v113
    v_and_b32 v226, 2047, v226
    v_mad_u32_u24 v226, v226, s53, v112
    s_mul_i32 s48, s52, 384
    v_add_u32 v227, s48, v113
    v_and_b32 v227, 2047, v227
    v_mad_u32_u24 v227, v227, s53, v112
    s_mul_i32 s48, s52, 8
    v_add_u32 v228, s48, v113
    v_and_b32 v228, 2047, v228
    v_mad_u32_u24 v228, v228, s53, v112
    s_mul_i32 s48, s52, 136
    v_add_u32 v229, s48, v113
    v_and_b32 v229, 2047, v229
    v_mad_u32_u24 v229, v229, s53, v112
    s_mul_i32 s48, s52, 264
    v_add_u32 v230, s48, v113
    v_and_b32 v230, 2047, v230
    v_mad_u32_u24 v230, v230, s53, v112
    s_mul_i32 s48, s52, 392
    v_add_u32 v231, s48, v113
    v_and_b32 v231, 2047, v231
    v_mad_u32_u24 v231, v231, s53, v112
    s_and_b32 s48, s2, 7
    s_mul_i32 s48, s48, 384
    s_add_u32 s48, s48, 327680
    v_mul_u32_u24 v235, 6144, v0
    v_add_u32 v235, s48, v235
    s_cmp_eq_u32 s32, 0
    s_cselect_b32 s0, 0x00ff00ff, -1
    s_mov_b32 s1, s0
    v_mov_b32 v112, 100224
    s_mov_b32 s34, 100000
    s_add_u32 s48, s31, 5
Lgs:
    ds_read_b32 v113, v112 offset:4
    s_sub_u32 s34, s34, 1
    s_cbranch_scc1 Lgsd
    s_waitcnt lgkmcnt(0)
    v_cmp_ne_u32 vcc, s48, v113
    s_cbranch_vccnz Lgs
Lgsd:
    s_waitcnt lgkmcnt(0)
    s_mov_b32 exec_hi, 0x7fffff
    global_load_dword v13, v45, s[18:19]
    global_load_dword v14, v46, s[18:19]
    global_load_dword v15, v47, s[18:19]
    global_load_dword v16, v48, s[18:19]
    s_mov_b64 exec, -1
    s_branch Lb1
Lg1r_1:
    s_mov_b64 exec, vcc
    s_sub_u32 s34, s34, 1
    s_cbranch_scc1 Lg1d_3
    global_load_dwordx4 v[160:163], v184, s[28:29] sc1
    global_load_dwordx4 v[164:167], v185, s[28:29] sc1
    global_load_dwordx4 v[168:171], v186, s[28:29] sc1
    global_load_dwordx4 v[172:175], v187, s[28:29] sc1
    global_load_dwordx4 v[176:179], v188, s[28:29] sc1
    s_branch Lg1c_2
Lwprep:
    s_waitcnt vmcnt(0)
    v_lshlrev_b32 v132, 16, v4
    v_and_b32 v133, 0xffff0000, v4
    v_lshlrev_b32 v134, 16, v5
    v_and_b32 v135, 0xffff0000, v5
    v_lshlrev_b32 v136, 16, v6
    v_and_b32 v137, 0xffff0000, v6
    v_lshlrev_b32 v138, 16, v7
    v_and_b32 v139, 0xffff0000, v7
    v_lshlrev_b32 v140, 16, v8
    v_and_b32 v141, 0xffff0000, v8
    v_pk_add_f32 v[112:113], v[132:133], v[134:135]
    v_pk_mul_f32 v[114:115], v[132:133], v[132:133]
    v_pk_fma_f32 v[114:115], v[134:135], v[134:135], v[114:115]
    v_pk_add_f32 v[112:113], v[112:113], v[136:137]
    v_pk_fma_f32 v[114:115], v[136:137], v[136:137], v[114:115]
    v_pk_add_f32 v[112:113], v[112:113], v[138:139]
    v_pk_fma_f32 v[114:115], v[138:139], v[138:139], v[114:115]
    v_pk_add_f32 v[112:113], v[112:113], v[140:141]
    v_pk_fma_f32 v[114:115], v[140:141], v[140:141], v[114:115]
    v_add_f32 v112, v112, v113
    v_add_f32 v114, v114, v115
    s_nop 0
    v_add_f32_dpp v112, v112, v112 row_ror:8 row_mask:0xf bank_mask:0xf
    v_add_f32_dpp v114, v114, v114 row_ror:8 row_mask:0xf bank_mask:0xf
    s_nop 0
    v_add_f32_dpp v112, v112, v112 row_ror:4 row_mask:0xf bank_mask:0xf
    v_add_f32_dpp v114, v114, v114 row_ror:4 row_mask:0xf bank_mask:0xf
    s_nop 0
    v_add_f32_dpp v112, v112, v112 row_ror:2 row_mask:0xf bank_mask:0xf
    v_add_f32_dpp v114, v114, v114 row_ror:2 row_mask:0xf bank_mask:0xf
    s_nop 0
    v_add_f32_dpp v112, v112, v112 row_ror:1 row_mask:0xf bank_mask:0xf
    v_add_f32_dpp v114, v114, v114 row_ror:1 row_mask:0xf bank_mask:0xf
    s_nop 0
    v_add_f32_dpp v112, v112, v112 row_bcast:15 row_mask:0xa bank_mask:0xf
    v_add_f32_dpp v114, v114, v114 row_bcast:15 row_mask:0xa bank_mask:0xf
    s_nop 0
    v_add_f32_dpp v112, v112, v112 row_bcast:31 row_mask:0xc bank_mask:0xf
    v_add_f32_dpp v114, v114, v114 row_bcast:31 row_mask:0xc bank_mask:0xf
    v_readlane_b32 s48, v112, 63
    v_readlane_b32 s49, v114, 63
    v_mov_b32 v112, 0x3acccccd
    v_mul_f32 v113, s48, v112
    v_mul_f32 v114, s49, v112
    v_fma_f32 v114, -v113, v113, v114
    v_max_f32 v114, 0, v114
    v_add_f32 v114, 0x3727c5ac, v114
    v_rsq_f32 v114, v114
    s_nop 0
    v_mul_f32 v114, 0x2b800000, v114
    v_mul_f32_e64 v116, -v113, v114
    v_pk_fma_f32 v[132:133], v[132:133], v[114:115], v[116:117] op_sel_hi:[1,0,0]
    v_pk_fma_f32 v[134:135], v[134:135], v[114:115], v[116:117] op_sel_hi:[1,0,0]
    v_pk_fma_f32 v[136:137], v[136:137], v[114:115], v[116:117] op_sel_hi:[1,0,0]
    v_pk_fma_f32 v[138:139], v[138:139], v[114:115], v[116:117] op_sel_hi:[1,0,0]
    v_pk_fma_f32 v[140:141], v[140:141], v[114:115], v[116:117] op_sel_hi:[1,0,0]
    s_mul_i32 s48, s30, 272
    s_add_u32 s48, s48, 15360
    v_add_u32 v142, s48, v1
    s_mov_b32 s60, 0x3e9e377a
    s_mov_b32 s62, 0xbf4f1bbd
    s_mov_b32 s64, 0xbf737871
    s_mov_b32 s66, 0xbf167918
    v_mul_u32_u24 v144, 544, v3
    v_lshrrev_b32 v145, 2, v2
    v_lshl_add_u32 v144, v145, 6, v144
    v_and_b32 v145, 3, v2
    v_lshl_add_u32 v144, v145, 3, v144
    s_lshl_b32 s48, s32, 1
    s_max_u32 s48, s48, 1
    s_sub_u32 s48, s48, 1
    s_mul_i32 s48, s48, 2176
    s_add_u32 s48, s48, 15360
    v_add_u32 v144, s48, v144
    s_lshl_b32 s48, s30, 11
    s_mul_i32 s49, s2, 12544
    s_add_u32 s49, s48, s49
    s_add_u32 s49, s49, 2097152
    v_lshlrev_b32 v145, 9, v3
    v_lshl_add_u32 v145, v2, 4, v145
    s_add_u32 s42, s28, s49
    s_addc_u32 s43, s29, 0
    s_mul_i32 s49, s35, 16640
    s_add_u32 s48, s48, s49
    s_add_u32 s48, s48, 6291456
    s_add_u32 s44, s28, s48
    s_addc_u32 s45, s29, 0
    s_lshr_b32 s49, s35, 6
    s_and_b32 s50, s35, 7
    s_bfe_u32 s51, s35, 0x30003
    s_cmp_lt_u32 s50, 4
    s_cselect_b32 s52, 1, -1
    s_cselect_b32 s53, 0, 640
    s_lshl_b32 s50, s50, 4
    v_add_u32 v112, s50, v2
    v_mad_u32_u24 v112, v112, 5, s49
    v_mul_i32_i24 v112, s52, v112
    v_add_lshl_u32 v112, v112, s53, 1
    s_lshl_b32 s50, s30, 4
    s_add_u32 s50, s50, s51
    v_lshl_add_u32 v113, v3, 9, s50
    v_mul_i32_i24 v113, s52, v113
    s_movk_i32 s53, 642
    v_and_b32 v224, 2047, v113
    v_mad_u32_u24 v224, v224, s53, v112
    s_mul_i32 s48, s52, 128
    v_add_u32 v225, s48, v113
    v_and_b32 v225, 2047, v225
    v_mad_u32_u24 v225, v225, s53, v112
    s_mul_i32 s48, s52, 256
    v_add_u32 v226, s48, v113
    v_and_b32 v226, 2047, v226
    v_mad_u32_u24 v226, v226, s53, v112
    s_mul_i32 s48, s52, 384
    v_add_u32 v227, s48, v113
    v_and_b32 v227, 2047, v227
    v_mad_u32_u24 v227, v227, s53, v112
    s_mul_i32 s48, s52, 8
    v_add_u32 v228, s48, v113
    v_and_b32 v228, 2047, v228
    v_mad_u32_u24 v228, v228, s53, v112
    s_mul_i32 s48, s52, 136
    v_add_u32 v229, s48, v113
    v_and_b32 v229, 2047, v229
    v_mad_u32_u24 v229, v229, s53, v112
    s_mul_i32 s48, s52, 264
    v_add_u32 v230, s48, v113
    v_and_b32 v230, 2047, v230
    v_mad_u32_u24 v230, v230, s53, v112
    s_mul_i32 s48, s52, 392
    v_add_u32 v231, s48, v113
    v_and_b32 v231, 2047, v231
    v_mad_u32_u24 v231, v231, s53, v112
    s_and_b32 s48, s2, 7
    s_mul_i32 s48, s48, 384
    s_add_u32 s48, s48, 327680
    v_mul_u32_u24 v235, 6144, v0
    v_add_u32 v235, s48, v235
    s_cmp_eq_u32 s32, 0
    s_cselect_b32 s0, 0x00ff00ff, -1
    s_mov_b32 s1, s0
    s_cmp_lg_u32 s30, 6
    s_cbranch_scc1 Lw6a
    s_lshr_b32 s50, s2, 3
    s_and_b32 s49, s2, 7
    s_mul_i32 s51, s49, 384
    s_mul_i32 s52, s50, 61440
    s_add_u32 s51, s51, s52
    v_mul_u32_u24 v64, 43, v0
    v_lshrrev_b32 v64, 7, v64
    v_mul_u32_u24 v64, 2688, v64
    v_lshl_add_u32 v64, v0, 7, v64
    v_add_u32 v64, s51, v64
    s_mul_i32 s49, s49, 245760
    s_mul_i32 s50, s50, 7680
    s_add_u32 s49, s49, s50
    v_lshl_add_u32 v65, v0, 7, s49
    s_lshr_b32 s48, s2, 3
    s_mul_i32 s48, s48, 5
    v_mul_u32_u24 v68, 43, v0
    v_lshrrev_b32 v68, 7, v68
    v_mul_u32_u24 v68, 2688, v68
    v_lshl_add_u32 v68, v0, 7, v68
    s_mul_i32 s48, s48, 3072
    v_add_u32 v68, s48, v68
    s_and_b32 s48, s2, 7
    s_mul_i32 s48, s48, 384
    v_add_u32 v68, s48, v68
Lw6a:
    s_waitcnt vmcnt(0)
    v_mov_b32 v112, 100224
    s_mov_b32 s34, 100000
    s_add_u32 s48, s31, 5
Leg:
    ds_read_b32 v113, v112 offset:4
    s_sub_u32 s34, s34, 1
    s_cbranch_scc1 Legd
    s_waitcnt lgkmcnt(0)
    v_cmp_ne_u32 vcc, s48, v113
    s_cbranch_vccnz Leg
Legd:
    s_waitcnt lgkmcnt(0)
    s_cmp_ge_u32 s2, 168
    s_cbranch_scc1 Leg2
    global_load_ushort v72, v224, s[6:7]
    global_load_ushort v80, v224, s[8:9]
    global_load_ushort v73, v225, s[6:7]
    global_load_ushort v81, v225, s[8:9]
    global_load_ushort v74, v226, s[6:7]
    global_load_ushort v82, v226, s[8:9]
    global_load_ushort v75, v227, s[6:7]
    global_load_ushort v83, v227, s[8:9]
    global_load_ushort v76, v228, s[6:7]
    global_load_ushort v84, v228, s[8:9]
    global_load_ushort v77, v229, s[6:7]
    global_load_ushort v85, v229, s[8:9]
    global_load_ushort v78, v230, s[6:7]
    global_load_ushort v86, v230, s[8:9]
    global_load_ushort v79, v231, s[6:7]
    global_load_ushort v87, v231, s[8:9]
Leg2:
    s_branch Lb1
Lp1_idle:
    s_setprio 1
    s_cmp_eq_u32 s30, 6
    s_cbranch_scc1 Lp1_i2
    s_cmp_ge_u32 s2, 200
    s_cbranch_scc1 Lp1_i2
    v_permlane32_swap_b32 v28, v32
    v_permlane32_swap_b32 v29, v33
    v_permlane32_swap_b32 v30, v34
    v_permlane32_swap_b32 v31, v35
    v_add_f32 v28, v28, v32
    v_add_f32 v29, v29, v33
    v_add_f32 v30, v30, v34
    v_add_f32 v31, v31, v35
    s_nop 0
    v_permlane16_swap_b32 v28, v30
    v_permlane16_swap_b32 v29, v31
    v_add_f32 v28, v28, v30
    v_add_f32 v29, v29, v31
    s_nop 0
    v_add_f32_dpp v28, v28, v28 row_ror:8 row_mask:0xf bank_mask:0xf
    v_add_f32_dpp v29, v29, v29 row_ror:8 row_mask:0xf bank_mask:0xf
    ds_bpermute_b32 v32, v50, v28 offset:0
    ds_bpermute_b32 v33, v50, v29 offset:0
    ds_bpermute_b32 v34, v51, v28 offset:0
    ds_bpermute_b32 v35, v51, v29 offset:0
    ds_bpermute_b32 v36, v50, v28 offset:16
    ds_bpermute_b32 v37, v50, v29 offset:16
    ds_bpermute_b32 v38, v51, v28 offset:16
    ds_bpermute_b32 v39, v51, v29 offset:16
    s_mov_b32 s48, 0x7060500
    s_waitcnt lgkmcnt(7)
    v_perm_b32 v32, v32, v241, s48
    s_mov_b32 s48, 0x7060501
    s_waitcnt lgkmcnt(6)
    v_perm_b32 v33, v33, v241, s48
    s_mov_b32 s48, 0x7060502
    s_waitcnt lgkmcnt(5)
    v_perm_b32 v34, v34, v241, s48
    s_mov_b32 s48, 0x7060503
    s_waitcnt lgkmcnt(4)
    v_perm_b32 v35, v35, v241, s48
    s_mov_b64 exec, 0xff
    global_store_dwordx4 v49, v[32:35], s[28:29] offset:0 sc1
    s_mov_b64 exec, -1
    s_mov_b32 s48, 0x7060500
    s_waitcnt lgkmcnt(3)
    v_perm_b32 v36, v36, v241, s48
    s_mov_b32 s48, 0x7060501
    s_waitcnt lgkmcnt(2)
    v_perm_b32 v37, v37, v241, s48
    s_mov_b32 s48, 0x7060502
    s_waitcnt lgkmcnt(1)
    v_perm_b32 v38, v38, v241, s48
    s_mov_b32 s48, 0x7060503
    s_waitcnt lgkmcnt(0)
    v_perm_b32 v39, v39, v241, s48
    s_mov_b64 exec, 0xff
    global_store_dwordx4 v49, v[36:39], s[28:29] offset:128 sc1
    s_mov_b64 exec, -1
Lp1_i2:
    s_cmp_lg_u32 s30, 7
    s_cbranch_scc1 Lrgw_25
    s_lshl_b32 s48, s2, 3
    s_add_u32 s48, s48, 16384
    v_mul_u32_u24 v116, 2304, v0
    v_add_u32 v116, s48, v116
    v_not_b32 v117, v241
    s_mov_b64 exec, 0xff
    global_store_dwordx2 v116, v[116:117], s[28:29] sc1
    s_mov_b64 exec, -1
Lrgw_25:
    s_setprio 0
    s_cmp_ge_u32 s2, 168
    s_cbranch_scc1 Lidle2
    global_load_dword v247, v1, s[12:13] offset:0
    global_load_dword v248, v1, s[12:13] offset:256
    global_load_dword v249, v1, s[12:13] offset:512
    global_load_dword v250, v1, s[12:13] offset:768
    global_load_dword v251, v1, s[12:13] offset:1024
    s_branch Lp1_done
Lidle2:
    s_barrier
    global_load_dword v247, v1, s[12:13] offset:0
    global_load_dword v248, v1, s[12:13] offset:256
    global_load_dword v249, v1, s[12:13] offset:512
    global_load_dword v250, v1, s[12:13] offset:768
    global_load_dword v251, v1, s[12:13] offset:1024
    s_sub_u32 s48, s2, 200
    s_cmp_lt_u32 s48, 48
    s_cbranch_scc1 Lid_m
    s_cmp_ge_u32 s2, 248
    s_cbranch_scc1 Lid_s
    s_sub_u32 s50, s2, 168
    s_and_b32 s50, s50, 24
    s_add_u32 s50, s50, s30
    s_mul_i32 s50, s50, 15
    s_add_u32 s50, s50, 160
    v_mul_u32_u24 v224, 43, v0
    v_lshrrev_b32 v224, 7, v224
    v_mul_u32_u24 v224, 2688, v224
    v_lshl_add_u32 v224, v0, 7, v224
    s_mul_i32 s50, s50, 3072
    v_add_u32 v224, s50, v224
    s_and_b32 s50, s2, 7
    s_mul_i32 s50, s50, 384
    v_add_u32 v224, s50, v224
    s_mov_b32 exec_lo, 0xffffffff
    s_mov_b32 exec_hi, 0x1fff
    global_load_dword v225, v224, s[16:17]
    s_mov_b64 exec, -1
Lid_s:
    s_cmp_ge_u32 s30, 6
    s_cbranch_scc1 Lid_t
    s_cmp_lt_u32 s2, 248
    s_cbranch_scc1 Lid_t
    s_cmp_ge_u32 s30, 5
    s_cbranch_scc1 Lid_t
    s_mov_b32 s48, s30
    s_and_b32 s51, s2, 7
    s_mul_i32 s51, s51, 5
    s_add_u32 s51, s51, s48
    s_lshl_b32 s50, s51, 8
    v_lshl_add_u32 v189, v2, 4, s50
    v_add_u32 v184, 529408, v189
    v_add_u32 v185, 544768, v189
    v_add_u32 v186, 560128, v189
    v_add_u32 v187, 575488, v189
    v_add_u32 v188, 590848, v189
    s_waitcnt vmcnt(0)
    global_load_dwordx4 v[160:163], v184, s[28:29] sc1
    global_load_dwordx4 v[164:167], v185, s[28:29] sc1
    global_load_dwordx4 v[168:171], v186, s[28:29] sc1
    global_load_dwordx4 v[172:175], v187, s[28:29] sc1
    global_load_dwordx4 v[176:179], v188, s[28:29] sc1
    s_mul_i32 s51, s51, 26
    s_lshr_b32 s51, s51, 8
    s_cmp_eq_u32 s51, 2
    s_cselect_b32 s50, 1.0, 0
    s_cmp_eq_u32 s51, 0
    s_cselect_b32 s51, 0x5d4ccccd, 1.0
    v_mov_b32 v242, s50
    v_mov_b32 v244, s51
    s_mov_b32 s50, 105728
    v_mad_u32_u24 v189, v3, s50, v189
    v_add_u32 v189, 609280, v189
    v_add_u32 v190, 422912, v189
    s_mov_b32 s34, 100000
    s_bfe_u32 s48, s31, 0x80000
    s_bfe_u32 s49, s31, 0x80008
    s_bfe_u32 s50, s31, 0x80010
    s_bfe_u32 s51, s31, 0x80018
Lfzc_27:
    s_waitcnt vmcnt(4)
    v_xor_b32 v160, s48, v160
    v_xor_b32 v161, s49, v161
    v_xor_b32 v162, s50, v162
    v_xor_b32 v163, s51, v163
    v_or_b32 v180, v160, v161
    v_or3_b32 v180, v180, v162, v163
    s_waitcnt vmcnt(3)
    v_xor_b32 v164, s48, v164
    v_xor_b32 v165, s49, v165
    v_xor_b32 v166, s50, v166
    v_xor_b32 v167, s51, v167
    v_or3_b32 v180, v180, v164, v165
    v_or3_b32 v180, v180, v166, v167
    s_waitcnt vmcnt(2)
    v_xor_b32 v168, s48, v168
    v_xor_b32 v169, s49, v169
    v_xor_b32 v170, s50, v170
    v_xor_b32 v171, s51, v171
    v_or3_b32 v180, v180, v168, v169
    v_or3_b32 v180, v180, v170, v171
    s_waitcnt vmcnt(1)
    v_xor_b32 v172, s48, v172
    v_xor_b32 v173, s49, v173
    v_xor_b32 v174, s50, v174
    v_xor_b32 v175, s51, v175
    v_or3_b32 v180, v180, v172, v173
    v_or3_b32 v180, v180, v174, v175
    s_waitcnt vmcnt(0)
    v_xor_b32 v176, s48, v176
    v_xor_b32 v177, s49, v177
    v_xor_b32 v178, s50, v178
    v_xor_b32 v179, s51, v179
    v_or3_b32 v180, v180, v176, v177
    v_or3_b32 v180, v180, v178, v179
    v_and_b32 v180, 0xff, v180
    v_cmp_ne_u32 vcc, 0, v180
    s_cbranch_vccnz Lfzr_26
Lfzd_28:
    s_mov_b64 exec, -1
    v_pk_add_f32 v[160:161], v[160:161], v[164:165]
    v_pk_add_f32 v[168:169], v[168:169], v[172:173]
    v_pk_add_f32 v[162:163], v[162:163], v[166:167]
    v_pk_add_f32 v[170:171], v[170:171], v[174:175]
    v_pk_add_f32 v[160:161], v[160:161], v[176:177]
    v_pk_add_f32 v[162:163], v[162:163], v[178:179]
    v_pk_add_f32 v[160:161], v[160:161], v[168:169]
    v_pk_add_f32 v[162:163], v[162:163], v[170:171]
    v_cvt_pk_bf16_f32 v164, v160, v161
    v_cvt_pk_bf16_f32 v166, v162, v163
    v_lshlrev_b32 v160, 16, v164
    v_and_b32 v161, 0xffff0000, v164
    v_lshlrev_b32 v162, 16, v166
    v_and_b32 v163, 0xffff0000, v166
    v_pk_add_f32 v[160:161], v[160:161], v[242:243] op_sel_hi:[1,0]
    v_pk_add_f32 v[162:163], v[162:163], v[242:243] op_sel_hi:[1,0]
    v_cvt_pk_bf16_f32 v164, v160, v161
    v_cvt_pk_bf16_f32 v166, v162, v163
    v_lshlrev_b32 v160, 16, v164
    v_and_b32 v161, 0xffff0000, v164
    v_lshlrev_b32 v162, 16, v166
    v_and_b32 v163, 0xffff0000, v166
    v_pk_mul_f32 v[160:161], v[160:161], v[244:245] op_sel_hi:[1,0]
    v_pk_mul_f32 v[162:163], v[162:163], v[244:245] op_sel_hi:[1,0]
    s_mov_b32 s48, 0x7060500
    v_perm_b32 v160, v160, v241, s48
    s_mov_b32 s48, 0x7060501
    v_perm_b32 v161, v161, v241, s48
    s_mov_b32 s48, 0x7060502
    v_perm_b32 v162, v162, v241, s48
    s_mov_b32 s48, 0x7060503
    v_perm_b32 v163, v163, v241, s48
    global_store_dwordx4 v189, v[160:163], s[28:29] sc1
    global_store_dwordx4 v190, v[160:163], s[28:29] sc1
Lid_t:
    s_lshl_b32 s48, s33, 2
    v_add_lshl_u32 v147, v3, s48, 4
    v_lshlrev_b32 v132, 3, v0
    v_xor_b32 v147, v147, v132
    s_mul_i32 s48, s30, 512
    s_add_u32 s48, s48, 59136
    v_add_u32 v147, s48, v147
    s_mov_b32 s60, 0x3f1e377a
    s_mov_b32 s62, 0xbfcf1bbd
    s_mov_b32 s64, 0x3ff37871
    s_mov_b32 s66, 0x3f967918
    s_and_b32 s48, s2, 15
    s_lshl_b32 s48, s48, 4
    s_lshr_b32 s49, s2, 4
    s_add_u32 s48, s48, s49
    s_lshl_b32 s48, s48, 6
    s_mul_i32 s49, s30, 532480
    s_add_u32 s48, s48, s49
    s_add_u32 s48, s48, 6291456
    s_add_u32 s4, s28, s48
    s_addc_u32 s5, s29, 0
    s_add_u32 s20, s4, 66560
    s_addc_u32 s21, s5, 0
    v_lshrrev_b32 v159, 2, v2
    v_lshl_add_u32 v158, v159, 3, v3
    v_mul_u32_u24 v158, 16640, v158
    v_and_b32 v132, 3, v2
    v_lshl_add_u32 v158, v132, 4, v158
    v_and_b32 v159, 7, v0
    v_xor_b32 v159, v159, v3
    v_lshlrev_b32 v159, 4, v159
    v_lshl_add_u32 v159, v2, 7, v159
    s_lshl_b32 s48, s32, 1
    s_max_u32 s48, s48, 1
    s_sub_u32 s48, s48, 1
    s_mul_i32 s48, s48, 4096
    s_mul_i32 s49, s33, 20480
    s_add_u32 s48, s48, s49
    s_add_u32 s48, s48, 59136
    v_add_u32 v159, s48, v159
    v_xor_b32 v146, 64, v159
    s_cmp_eq_u32 s32, 0
    s_cselect_b64 s[0:1], 0xffff, -1
    s_waitcnt vmcnt(0)
    v_lshlrev_b32 v148, 16, v247
    v_and_b32 v149, 0xffff0000, v247
    v_lshlrev_b32 v150, 16, v248
    v_and_b32 v151, 0xffff0000, v248
    v_lshlrev_b32 v152, 16, v249
    v_and_b32 v153, 0xffff0000, v249
    v_lshlrev_b32 v154, 16, v250
    v_and_b32 v155, 0xffff0000, v250
    v_lshlrev_b32 v156, 16, v251
    v_and_b32 v157, 0xffff0000, v251
    v_mov_b32 v252, 0x3acccccd
    v_mov_b32 v253, 0x3727c5ac
    v_mov_b32 v254, 0x7f7ff800
    v_mov_b32 v255, 0x7ff
    s_lshl_b32 s48, s30, 2
    s_add_u32 s48, s48, 100096
    v_mov_b32 v9, s48
    v_and_b32 v10, 28, v1
    v_add_u32 v10, 100096, v10
    s_lshl_b32 s48, s2, 3
    s_add_u32 s48, s48, 16384
    v_mul_u32_u24 v11, 2304, v0
    v_add_u32 v11, s48, v11
    s_lshl_b32 s48, s30, 3
    s_add_u32 s48, s48, 100160
    v_lshl_add_u32 v234, v3, 2, s48
    s_cmp_lg_u32 s30, 7
    s_cbranch_scc1 Lcan_b
    s_lshl_b32 s48, s2, 7
    s_add_u32 s48, s48, -17408
    v_mov_b32 v113, s48
    v_mov_b32 v114, 0
    s_mov_b64 exec, 1
    s_mov_b32 s34, 100000
Lpoll_29:
    global_atomic_add v112, v113, v114, s[28:29] sc0 sc1
    s_waitcnt vmcnt(0)
    v_cmp_ne_u32 vcc, s31, v112
    s_cbranch_vccz Lok_30
    s_mov_b64 exec, vcc
    s_sub_u32 s34, s34, 1
    s_cbranch_scc0 Lpoll_29
Lok_30:
    s_mov_b64 exec, -1
Lcan_b:
    s_barrier
    s_add_u32 s49, s39, 87552
    v_add_u32 v100, s49, v232
    s_cmp_ge_u32 s30, 5
    s_cbranch_scc1 Lfl2
    global_load_dwordx4 v[88:91], v100, s[28:29] offset:-2560 sc1
    global_load_dwordx4 v[92:95], v100, s[28:29] offset:2560 sc1
Lfl2:
    s_branch Lp3s_done
Lid_m:
    s_and_b32 s38, s2, 7
    s_mul_i32 s38, s38, 6
    s_lshr_b32 s48, s48, 3
    s_add_u32 s38, s38, s48
    s_min_u32 s49, s30, 4
    s_mul_i32 s48, s38, 40960
    s_lshl_b32 s49, s49, 8
    s_add_u32 s48, s48, s49
    s_add_u32 s48, s48, 3840
    v_mul_u32_u24 v9, 10240, v3
    v_lshl_add_u32 v9, v2, 4, v9
    v_add_u32 v9, s48, v9
    v_add_u32 v10, 5120, v9
    s_cmp_ge_u32 s30, 5
    s_cselect_b64 exec, 1, -1
    global_load_dwordx4 v[200:203], v9, s[18:19] offset:-3840
    global_load_dwordx4 v[204:207], v9, s[18:19] offset:-2560
    global_load_dwordx4 v[208:211], v9, s[18:19] offset:-1280
    global_load_dwordx4 v[212:215], v9, s[18:19] offset:0
    global_load_dwordx4 v[216:219], v9, s[18:19] offset:1280
    global_load_dwordx4 v[220:223], v9, s[18:19] offset:2560
    global_load_dwordx4 v[224:227], v9, s[18:19] offset:3840
    global_load_dwordx4 v[228:231], v10, s[18:19]
    s_mov_b64 exec, -1
    s_cmp_eq_u32 s33, 0
    s_cselect_b32 s40, s14, s16
    s_cselect_b32 s41, s15, s17
    s_mul_i32 s48, s32, 491520
    s_lshl_b32 s49, s38, 6
    s_add_u32 s48, s48, s49
    v_lshrrev_b32 v9, 2, v0
    v_mul_u32_u24 v9, 6144, v9
    v_and_b32 v10, 3, v0
    v_lshl_add_u32 v9, v10, 4, v9
    v_add_u32 v9, s48, v9
    global_load_dwordx4 v[160:163], v9, s[40:41]
    global_load_dwordx4 v[164:167], v9, s[40:41] offset:3072
    v_add_u32 v9, 98304, v9
    global_load_dwordx4 v[168:171], v9, s[40:41]
    global_load_dwordx4 v[172:175], v9, s[40:41] offset:3072
    v_add_u32 v9, 98304, v9
    global_load_dwordx4 v[176:179], v9, s[40:41]
    global_load_dwordx4 v[180:183], v9, s[40:41] offset:3072
    v_add_u32 v9, 98304, v9
    global_load_dwordx4 v[184:187], v9, s[40:41]
    global_load_dwordx4 v[188:191], v9, s[40:41] offset:3072
    v_add_u32 v9, 98304, v9
    global_load_dwordx4 v[192:195], v9, s[40:41]
    global_load_dwordx4 v[196:199], v9, s[40:41] offset:3072
    s_cmp_ge_u32 s30, 6
    s_cbranch_scc1 Lid_n
Lid_n:
    s_lshl_b32 s48, s33, 2
    v_add_lshl_u32 v147, v3, s48, 4
    v_lshlrev_b32 v132, 3, v0
    v_xor_b32 v147, v147, v132
    s_mul_i32 s48, s30, 512
    s_add_u32 s48, s48, 59136
    v_add_u32 v147, s48, v147
    s_mov_b32 s60, 0x3f1e377a
    s_mov_b32 s62, 0xbfcf1bbd
    s_mov_b32 s64, 0x3ff37871
    s_mov_b32 s66, 0x3f967918
    s_and_b32 s48, s2, 15
    s_lshl_b32 s48, s48, 4
    s_lshr_b32 s49, s2, 4
    s_add_u32 s48, s48, s49
    s_lshl_b32 s48, s48, 6
    s_mul_i32 s49, s30, 532480
    s_add_u32 s48, s48, s49
    s_add_u32 s48, s48, 6291456
    s_add_u32 s4, s28, s48
    s_addc_u32 s5, s29, 0
    s_add_u32 s20, s4, 66560
    s_addc_u32 s21, s5, 0
    v_lshrrev_b32 v159, 2, v2
    v_lshl_add_u32 v158, v159, 3, v3
    v_mul_u32_u24 v158, 16640, v158
    v_and_b32 v132, 3, v2
    v_lshl_add_u32 v158, v132, 4, v158
    v_and_b32 v159, 7, v0
    v_xor_b32 v159, v159, v3
    v_lshlrev_b32 v159, 4, v159
    v_lshl_add_u32 v159, v2, 7, v159
    s_lshl_b32 s48, s32, 1
    s_max_u32 s48, s48, 1
    s_sub_u32 s48, s48, 1
    s_mul_i32 s48, s48, 4096
    s_mul_i32 s49, s33, 20480
    s_add_u32 s48, s48, s49
    s_add_u32 s48, s48, 59136
    v_add_u32 v159, s48, v159
    v_xor_b32 v146, 64, v159
    s_cmp_eq_u32 s32, 0
    s_cselect_b64 s[0:1], 0xffff, -1
    s_waitcnt vmcnt(18)
    v_lshlrev_b32 v148, 16, v247
    v_and_b32 v149, 0xffff0000, v247
    v_lshlrev_b32 v150, 16, v248
    v_and_b32 v151, 0xffff0000, v248
    v_lshlrev_b32 v152, 16, v249
    v_and_b32 v153, 0xffff0000, v249
    v_lshlrev_b32 v154, 16, v250
    v_and_b32 v155, 0xffff0000, v250
    v_lshlrev_b32 v156, 16, v251
    v_and_b32 v157, 0xffff0000, v251
    v_mov_b32 v252, 0x3acccccd
    v_mov_b32 v253, 0x3727c5ac
    v_mov_b32 v254, 0x7f7ff800
    v_mov_b32 v255, 0x7ff
    s_lshl_b32 s48, s30, 2
    s_add_u32 s48, s48, 100096
    v_mov_b32 v9, s48
    v_and_b32 v10, 28, v1
    v_add_u32 v10, 100096, v10
    s_lshl_b32 s48, s2, 3
    s_add_u32 s48, s48, 16384
    v_mul_u32_u24 v11, 2304, v0
    v_add_u32 v11, s48, v11
    s_lshl_b32 s48, s30, 3
    s_add_u32 s48, s48, 100160
    v_lshl_add_u32 v234, v3, 2, s48
    s_waitcnt vmcnt(0)
    s_barrier
    s_add_u32 s49, s39, 87552
    v_add_u32 v100, s49, v232
    s_cmp_ge_u32 s30, 5
    s_cbranch_scc1 Lfl3
    global_load_dwordx4 v[88:91], v100, s[28:29] offset:-2560 sc1
    global_load_dwordx4 v[92:95], v100, s[28:29] offset:2560 sc1
Lfl3:
    s_branch Lp3s_done
Lb3w:
    s_cmp_lg_u32 s30, 5
    s_cbranch_scc1 Lb3
    s_waitcnt vmcnt(5)
    s_branch Lb3
Lz1r_4:
    s_sub_u32 s34, s34, 1
    s_cbranch_scc1 Lz1d_6
    global_load_dword v112, v160, s[40:41] sc1
    global_load_dword v113, v161, s[40:41] sc1
    global_load_dword v114, v162, s[40:41] sc1
    global_load_dword v115, v163, s[40:41] sc1
    global_load_dword v116, v160, s[46:47] sc1
    global_load_dword v117, v161, s[46:47] sc1
    global_load_dword v118, v162, s[46:47] sc1
    global_load_dword v119, v163, s[46:47] sc1
    s_waitcnt vmcnt(0)
    s_branch Lz1c_5
Lg3r_9:
    s_mov_b64 exec, vcc
    s_sub_u32 s34, s34, 1
    s_cbranch_scc1 Lg3d_11
    global_load_dwordx4 v[88:91], v100, s[28:29] offset:-2560 sc1
    global_load_dwordx4 v[92:95], v100, s[28:29] offset:2560 sc1
    s_branch Lg3c_10
Lb6w:
    s_bfe_u32 s48, s2, 0x40000
    s_mul_i32 s48, s48, 6144
    s_add_u32 s48, s48, 330752
    v_mul_u32_u24 v36, 384, v0
    v_add_u32 v36, s48, v36
    v_mov_b32 v37, 0
    s_mov_b64 exec, 0xff
    s_mov_b32 s34, 64
Lhw_33:
    global_atomic_add v38, v36, v37, s[28:29] sc0 sc1
    s_waitcnt vmcnt(0)
    v_cmp_ne_u32 vcc, 21, v38
    s_cbranch_vccz Lhd_34
    s_mov_b64 exec, vcc
    s_sub_u32 s34, s34, 1
    s_cbranch_scc0 Lhw_33
Lhd_34:
    s_mov_b64 exec, -1
    s_branch Lb6x
Lp3_idle:
    v_pk_mul_f32 v[122:123], v[74:75], v[148:149]
    v_pk_fma_f32 v[122:123], v[78:79], v[150:151], v[122:123]
    v_pk_fma_f32 v[122:123], v[82:83], v[152:153], v[122:123]
    v_pk_fma_f32 v[122:123], v[86:87], v[154:155], v[122:123]
    v_pk_fma_f32 v[122:123], v[90:91], v[156:157], v[122:123]
    v_pk_mul_f32 v[148:149], v[148:149], v[92:93]
    v_pk_mul_f32 v[150:151], v[150:151], v[96:97]
    v_pk_mul_f32 v[152:153], v[152:153], v[100:101]
    v_pk_mul_f32 v[154:155], v[154:155], v[104:105]
    v_pk_mul_f32 v[156:157], v[156:157], v[108:109]
    v_pk_add_f32 v[120:121], v[148:149], v[150:151]
    v_pk_add_f32 v[120:121], v[120:121], v[152:153]
    v_pk_add_f32 v[120:121], v[120:121], v[154:155]
    v_pk_add_f32 v[120:121], v[120:121], v[156:157]
    v_add_f32 v120, v120, v121
    v_add_f32 v122, v122, v123
    s_nop 0
    v_add_f32_dpp v120, v120, v120 row_ror:8 row_mask:0xf bank_mask:0xf
    v_add_f32_dpp v122, v122, v122 row_ror:8 row_mask:0xf bank_mask:0xf
    s_nop 0
    v_add_f32_dpp v120, v120, v120 row_ror:4 row_mask:0xf bank_mask:0xf
    v_add_f32_dpp v122, v122, v122 row_ror:4 row_mask:0xf bank_mask:0xf
    s_nop 0
    v_add_f32_dpp v120, v120, v120 row_ror:2 row_mask:0xf bank_mask:0xf
    v_add_f32_dpp v122, v122, v122 row_ror:2 row_mask:0xf bank_mask:0xf
    s_nop 0
    v_add_f32_dpp v120, v120, v120 row_ror:1 row_mask:0xf bank_mask:0xf
    v_add_f32_dpp v122, v122, v122 row_ror:1 row_mask:0xf bank_mask:0xf
    s_nop 0
    v_add_f32_dpp v120, v120, v120 row_bcast:15 row_mask:0xa bank_mask:0xf
    v_add_f32_dpp v122, v122, v122 row_bcast:15 row_mask:0xa bank_mask:0xf
    s_nop 0
    v_add_f32_dpp v120, v120, v120 row_bcast:31 row_mask:0xc bank_mask:0xf
    v_add_f32_dpp v122, v122, v122 row_bcast:31 row_mask:0xc bank_mask:0xf
    v_readlane_b32 s56, v120, 63
    v_readlane_b32 s57, v122, 63
    s_nop 0
    v_mov_b32 v120, s56
    v_mov_b32 v121, s57
    v_mov_b32 v122, 100232
    ds_write_b64 v122, v[120:121]
    s_waitcnt vmcnt(0)
    s_branch Lp3_skip
Lz2r_12:
    s_sub_u32 s34, s34, 1
    s_cbranch_scc1 Lz2d_14
    global_load_dwordx4 v[112:115], v158, s[4:5] sc1
    v_mov_b64 v[116:117], v[236:237]
    v_mov_b64 v[118:119], v[238:239]
    s_mov_b64 exec, s[0:1]
    global_load_dwordx4 v[116:119], v158, s[20:21] sc1
    s_mov_b64 exec, -1
    s_waitcnt vmcnt(0)
    s_branch Lz2c_13
Lh2r:
    s_sub_u32 s34, s34, 1
    s_cbranch_scc1 Lh2d
    global_load_dwordx2 v[14:15], v112, s[28:29] offset:0 sc1
    global_load_dwordx2 v[16:17], v112, s[28:29] offset:256 sc1
    global_load_dwordx2 v[18:19], v112, s[28:29] offset:512 sc1
    global_load_dwordx2 v[20:21], v112, s[28:29] offset:768 sc1
    global_load_dwordx2 v[22:23], v112, s[28:29] offset:1024 sc1
    s_waitcnt vmcnt(0)
    s_branch Lh2c
Lfzr_26:
    s_mov_b64 exec, vcc
    s_sub_u32 s34, s34, 1
    s_cbranch_scc1 Lfzd_28
    global_load_dwordx4 v[160:163], v184, s[28:29] sc1
    global_load_dwordx4 v[164:167], v185, s[28:29] sc1
    global_load_dwordx4 v[168:171], v186, s[28:29] sc1
    global_load_dwordx4 v[172:175], v187, s[28:29] sc1
    global_load_dwordx4 v[176:179], v188, s[28:29] sc1
    s_branch Lfzc_27
k0_end:
    s_endpgm
Lcode_end:
.section .rodata,"a"
.p2align 6
.amdhsa_kernel adaLN_cond__spectral_gfnet__moe_arch_mod__prompt_kernel
  .amdhsa_next_free_vgpr 256
  .amdhsa_next_free_sgpr 68
  .amdhsa_accum_offset 256
  .amdhsa_group_segment_fixed_size 0
  .amdhsa_kernarg_size 104
  .amdhsa_user_sgpr_count 2
  .amdhsa_user_sgpr_kernarg_segment_ptr 1
  .amdhsa_system_sgpr_workgroup_id_x 1
  .amdhsa_float_denorm_mode_32 3
.end_amdhsa_kernel
```
